```python
import torch

def _softmax(x, axis=-1):
    return torch.softmax(x, dim=axis)
def _gelu(x):
    return torch.nn.functional.gelu(x, approximate="tanh")
def _silu(x):
    return torch.nn.functional.silu(x)
def _sigmoid(x):
    return torch.sigmoid(x)
def _layernorm(x, axis=-1, eps=1e-5):
    m = x.mean(dim=axis, keepdim=True)
    v = x.var(dim=axis, keepdim=True, unbiased=False)
    return (x - m) / torch.sqrt(v + eps)
def _scatter_add(tgt, idx, src, axis=0):
    return tgt.clone().index_add_(axis, idx, src)
def _segment_sum(src, seg, n):
    out = torch.zeros((n,) + src.shape[1:], dtype=src.dtype)
    return out.index_add_(0, seg, src)
def _pad(x, pw):
    flat = tuple(v for pair in reversed(pw) for v in pair)
    return torch.nn.functional.pad(x, flat)

kernel_name = 'gather_scatter__cheap_equivariant_egnn__graph'

def setup_inputs():

    _w = (lambda a: (lambda t: t.to(torch.bfloat16) if t.is_floating_point() else t)(torch.as_tensor(a)))
    N, deg, D, De = 10000, 16, 256, max(0, 1)
    E = N * deg
    return {
        "h": _w((lambda *s: torch.randn(*s, dtype=torch.bfloat16) * 0.2)(N, D)),
        "pos": _w((lambda *s: torch.randn(*s, dtype=torch.bfloat16) * 0.8)(N, 3)),
        "e_attr": _w((lambda *s: torch.randn(*s, dtype=torch.bfloat16) * 0.8)(E, De)),
        "src": _w((lambda lo, hi, *s: torch.randint(lo, hi, s))(0, N, E).to(torch.int64)),
        "dst": _w((lambda lo, hi, *s: torch.randint(lo, hi, s))(0, N, E).to(torch.int64)),
        "w_e": _w(0.1 * (lambda *s: torch.randn(*s, dtype=torch.bfloat16) * 0.8)(2 * D + 1 + De, D)),
        "w_x": _w(0.1 * (lambda *s: torch.randn(*s, dtype=torch.bfloat16) * 0.2)(D, 1)),
        "w_h": _w(0.1 * (lambda *s: torch.randn(*s, dtype=torch.bfloat16) * 0.2)(2 * D, D)),
    }

def reference(h, pos, e_attr, src, dst, w_e, w_x, w_h):
    N, D = h.shape[0], h.shape[1]
    diff = pos[dst] - pos[src]
    dist2 = torch.sum(diff * diff, axis=-1, keepdims=True)
    e_in = torch.concatenate([h[dst], h[src], dist2, e_attr], axis=-1)
    m_ij = _silu(e_in @ w_e)
    coord_scale = m_ij @ w_x
    pos_new = pos + _segment_sum(diff * coord_scale, dst, N)
    m_i = _segment_sum(m_ij, dst, N)
    h_new = h + _silu(torch.concatenate([h, m_i], axis=-1) @ w_h)
    return h_new, pos_new
```

```asm
; @launch kernel=k1_kernel grid=(250,1,1) block=(512,1,1) lds=151552
; @launch kernel=k2_kernel grid=(250,1,1) block=(1024,1,1) lds=151552
.amdgcn_target "amdgcn-amd-amdhsa--gfx950"
.text
.globl k1_kernel
.p2align 8
.type k1_kernel,@function
k1_kernel:
    s_cmp_ge_u32 s2, 250
    s_cbranch_scc1 k1_end
    s_load_dwordx4 s[4:7], s[0:1], 0
    s_load_dwordx4 s[8:11], s[0:1], 16
    s_load_dwordx4 s[12:15], s[0:1], 32
    s_load_dwordx4 s[16:19], s[0:1], 48
    s_load_dwordx2 s[20:21], s[0:1], 80
    v_lshrrev_b32 v1, 6, v0
    v_and_b32 v0, 63, v0
    v_readfirstlane_b32 s3, v1
    s_waitcnt lgkmcnt(0)
    s_mov_b32 s24, s20
    s_mov_b32 s25, s21
    s_mov_b32 s26, 21766144
    s_mov_b32 s27, 0x00020000
    s_cmp_ge_u32 s3, 4
    s_cbranch_scc1 k1_sort
    s_mov_b32 s28, s4
    s_mov_b32 s29, s5
    s_mov_b32 s30, 5120000
    s_mov_b32 s31, 0x00020000
    s_mov_b32 s32, s14
    s_mov_b32 s33, s15
    s_mov_b32 s34, 263168
    s_mov_b32 s35, 0x00020000
    s_lshr_b32 s36, s2, 1
    s_and_b32 s37, s2, 1
    v_lshrrev_b32 v1, 3, v0
    v_lshlrev_b32 v2, 9, v1
    v_and_b32 v3, 7, v0
    v_lshlrev_b32 v3, 4, v3
    v_add_u32 v2, v2, v3
    s_lshl_b32 s38, s3, 7
    s_lshl_b32 s39, s37, 17
    s_add_u32 s38, s38, s39
    v_add_u32 v2, s38, v2
    v_mul_u32_u24 v4, 144, v1
    v_add_u32 v4, v4, v3
    s_mul_i32 s39, s3, 36864
    v_add_u32 v4, s39, v4
    v_and_b32 v5, 15, v0
    v_lshlrev_b32 v5, 9, v5
    v_lshrrev_b32 v6, 4, v0
    v_lshlrev_b32 v7, 4, v6
    v_add_u32 v5, v5, v7
    s_mul_i32 s39, s36, 40960
    v_add_u32 v5, s39, v5
    v_lshlrev_b32 v7, 3, v6
    v_and_b32 v8, 15, v0
    v_lshrrev_b32 v8, 2, v8
    v_add_u32 v7, v7, v8
    v_mul_u32_u24 v7, 144, v7
    v_and_b32 v8, 3, v0
    v_lshlrev_b32 v8, 3, v8
    v_add_u32 v7, v7, v8
    s_mul_i32 s39, s3, 36864
    v_add_u32 v7, s39, v7
    s_mov_b32 s40, 0
    buffer_load_dwordx4 v[168:171], v2, s[32:35], s40 offen
    s_mov_b32 s40, 4096
    buffer_load_dwordx4 v[172:175], v2, s[32:35], s40 offen
    s_mov_b32 s40, 8192
    buffer_load_dwordx4 v[176:179], v2, s[32:35], s40 offen
    s_mov_b32 s40, 12288
    buffer_load_dwordx4 v[180:183], v2, s[32:35], s40 offen
    s_mov_b32 s40, 16384
    buffer_load_dwordx4 v[184:187], v2, s[32:35], s40 offen
    s_mov_b32 s40, 20480
    buffer_load_dwordx4 v[188:191], v2, s[32:35], s40 offen
    s_mov_b32 s40, 24576
    buffer_load_dwordx4 v[192:195], v2, s[32:35], s40 offen
    s_mov_b32 s40, 28672
    buffer_load_dwordx4 v[196:199], v2, s[32:35], s40 offen
    s_mov_b32 s40, 32768
    buffer_load_dwordx4 v[200:203], v2, s[32:35], s40 offen
    s_mov_b32 s40, 36864
    buffer_load_dwordx4 v[204:207], v2, s[32:35], s40 offen
    s_mov_b32 s40, 40960
    buffer_load_dwordx4 v[208:211], v2, s[32:35], s40 offen
    s_mov_b32 s40, 45056
    buffer_load_dwordx4 v[212:215], v2, s[32:35], s40 offen
    s_mov_b32 s40, 49152
    buffer_load_dwordx4 v[216:219], v2, s[32:35], s40 offen
    s_mov_b32 s40, 53248
    buffer_load_dwordx4 v[220:223], v2, s[32:35], s40 offen
    s_mov_b32 s40, 57344
    buffer_load_dwordx4 v[224:227], v2, s[32:35], s40 offen
    s_mov_b32 s40, 61440
    buffer_load_dwordx4 v[228:231], v2, s[32:35], s40 offen
    s_mov_b32 s40, 0
    buffer_load_dwordx4 v[56:59], v5, s[28:31], s40 offen offset:0
    s_mov_b32 s40, 8192
    buffer_load_dwordx4 v[60:63], v5, s[28:31], s40 offen offset:0
    s_mov_b32 s40, 16384
    buffer_load_dwordx4 v[64:67], v5, s[28:31], s40 offen offset:0
    s_mov_b32 s40, 24576
    buffer_load_dwordx4 v[68:71], v5, s[28:31], s40 offen offset:0
    s_mov_b32 s40, 32768
    buffer_load_dwordx4 v[72:75], v5, s[28:31], s40 offen offset:0
    s_mov_b32 s40, 0
    buffer_load_dwordx4 v[76:79], v5, s[28:31], s40 offen offset:64
    s_mov_b32 s40, 8192
    buffer_load_dwordx4 v[80:83], v5, s[28:31], s40 offen offset:64
    s_mov_b32 s40, 16384
    buffer_load_dwordx4 v[84:87], v5, s[28:31], s40 offen offset:64
    s_mov_b32 s40, 24576
    buffer_load_dwordx4 v[88:91], v5, s[28:31], s40 offen offset:64
    s_mov_b32 s40, 32768
    buffer_load_dwordx4 v[92:95], v5, s[28:31], s40 offen offset:64
    s_mov_b32 s40, 0
    buffer_load_dwordx4 v[96:99], v5, s[28:31], s40 offen offset:128
    s_mov_b32 s40, 8192
    buffer_load_dwordx4 v[100:103], v5, s[28:31], s40 offen offset:128
    s_mov_b32 s40, 16384
    buffer_load_dwordx4 v[104:107], v5, s[28:31], s40 offen offset:128
    s_mov_b32 s40, 24576
    buffer_load_dwordx4 v[108:111], v5, s[28:31], s40 offen offset:128
    s_mov_b32 s40, 32768
    buffer_load_dwordx4 v[112:115], v5, s[28:31], s40 offen offset:128
    s_mov_b32 s40, 0
    buffer_load_dwordx4 v[116:119], v5, s[28:31], s40 offen offset:192
    s_mov_b32 s40, 8192
    buffer_load_dwordx4 v[120:123], v5, s[28:31], s40 offen offset:192
    s_mov_b32 s40, 16384
    buffer_load_dwordx4 v[124:127], v5, s[28:31], s40 offen offset:192
    s_mov_b32 s40, 24576
    buffer_load_dwordx4 v[128:131], v5, s[28:31], s40 offen offset:192
    s_mov_b32 s40, 32768
    buffer_load_dwordx4 v[132:135], v5, s[28:31], s40 offen offset:192
    s_waitcnt vmcnt(28)
    ds_write_b128 v4, v[168:171] offset:0
    ds_write_b128 v4, v[172:175] offset:1152
    ds_write_b128 v4, v[176:179] offset:2304
    ds_write_b128 v4, v[180:183] offset:3456
    ds_write_b128 v4, v[184:187] offset:4608
    ds_write_b128 v4, v[188:191] offset:5760
    ds_write_b128 v4, v[192:195] offset:6912
    ds_write_b128 v4, v[196:199] offset:8064
    s_mov_b32 s40, 65536
    buffer_load_dwordx4 v[168:171], v2, s[32:35], s40 offen
    s_mov_b32 s40, 69632
    buffer_load_dwordx4 v[172:175], v2, s[32:35], s40 offen
    s_mov_b32 s40, 73728
    buffer_load_dwordx4 v[176:179], v2, s[32:35], s40 offen
    s_mov_b32 s40, 77824
    buffer_load_dwordx4 v[180:183], v2, s[32:35], s40 offen
    s_mov_b32 s40, 81920
    buffer_load_dwordx4 v[184:187], v2, s[32:35], s40 offen
    s_mov_b32 s40, 86016
    buffer_load_dwordx4 v[188:191], v2, s[32:35], s40 offen
    s_mov_b32 s40, 90112
    buffer_load_dwordx4 v[192:195], v2, s[32:35], s40 offen
    s_mov_b32 s40, 94208
    buffer_load_dwordx4 v[196:199], v2, s[32:35], s40 offen
    s_waitcnt vmcnt(28)
    ds_write_b128 v4, v[200:203] offset:9216
    ds_write_b128 v4, v[204:207] offset:10368
    ds_write_b128 v4, v[208:211] offset:11520
    ds_write_b128 v4, v[212:215] offset:12672
    ds_write_b128 v4, v[216:219] offset:13824
    ds_write_b128 v4, v[220:223] offset:14976
    ds_write_b128 v4, v[224:227] offset:16128
    ds_write_b128 v4, v[228:231] offset:17280
    s_mov_b32 s40, 98304
    buffer_load_dwordx4 v[200:203], v2, s[32:35], s40 offen
    s_mov_b32 s40, 102400
    buffer_load_dwordx4 v[204:207], v2, s[32:35], s40 offen
    s_mov_b32 s40, 106496
    buffer_load_dwordx4 v[208:211], v2, s[32:35], s40 offen
    s_mov_b32 s40, 110592
    buffer_load_dwordx4 v[212:215], v2, s[32:35], s40 offen
    s_mov_b32 s40, 114688
    buffer_load_dwordx4 v[216:219], v2, s[32:35], s40 offen
    s_mov_b32 s40, 118784
    buffer_load_dwordx4 v[220:223], v2, s[32:35], s40 offen
    s_mov_b32 s40, 122880
    buffer_load_dwordx4 v[224:227], v2, s[32:35], s40 offen
    s_mov_b32 s40, 126976
    buffer_load_dwordx4 v[228:231], v2, s[32:35], s40 offen
    s_waitcnt vmcnt(8)
    ds_write_b128 v4, v[168:171] offset:18432
    ds_write_b128 v4, v[172:175] offset:19584
    ds_write_b128 v4, v[176:179] offset:20736
    ds_write_b128 v4, v[180:183] offset:21888
    ds_write_b128 v4, v[184:187] offset:23040
    ds_write_b128 v4, v[188:191] offset:24192
    ds_write_b128 v4, v[192:195] offset:25344
    ds_write_b128 v4, v[196:199] offset:26496
    s_waitcnt vmcnt(0)
    ds_write_b128 v4, v[200:203] offset:27648
    ds_write_b128 v4, v[204:207] offset:28800
    ds_write_b128 v4, v[208:211] offset:29952
    ds_write_b128 v4, v[212:215] offset:31104
    ds_write_b128 v4, v[216:219] offset:32256
    ds_write_b128 v4, v[220:223] offset:33408
    ds_write_b128 v4, v[224:227] offset:34560
    ds_write_b128 v4, v[228:231] offset:35712
    s_waitcnt lgkmcnt(0)
    ds_read_b64_tr_b16 v[136:137], v7 offset:0
    ds_read_b64_tr_b16 v[138:139], v7 offset:576
    ds_read_b64_tr_b16 v[140:141], v7 offset:32
    ds_read_b64_tr_b16 v[142:143], v7 offset:608
    ds_read_b64_tr_b16 v[144:145], v7 offset:64
    ds_read_b64_tr_b16 v[146:147], v7 offset:640
    ds_read_b64_tr_b16 v[148:149], v7 offset:96
    ds_read_b64_tr_b16 v[150:151], v7 offset:672
    ds_read_b64_tr_b16 v[152:153], v7 offset:4608
    ds_read_b64_tr_b16 v[154:155], v7 offset:5184
    ds_read_b64_tr_b16 v[156:157], v7 offset:4640
    ds_read_b64_tr_b16 v[158:159], v7 offset:5216
    ds_read_b64_tr_b16 v[160:161], v7 offset:4672
    ds_read_b64_tr_b16 v[162:163], v7 offset:5248
    ds_read_b64_tr_b16 v[164:165], v7 offset:4704
    ds_read_b64_tr_b16 v[166:167], v7 offset:5280
    s_waitcnt vmcnt(20) lgkmcnt(8)
    v_mfma_f32_16x16x32_bf16 v[168:171], v[136:139], v[56:59], 0
    v_mfma_f32_16x16x32_bf16 v[172:175], v[140:143], v[56:59], 0
    v_mfma_f32_16x16x32_bf16 v[176:179], v[144:147], v[56:59], 0
    v_mfma_f32_16x16x32_bf16 v[180:183], v[148:151], v[56:59], 0
    v_mfma_f32_16x16x32_bf16 v[184:187], v[136:139], v[60:63], 0
    v_mfma_f32_16x16x32_bf16 v[188:191], v[140:143], v[60:63], 0
    v_mfma_f32_16x16x32_bf16 v[192:195], v[144:147], v[60:63], 0
    v_mfma_f32_16x16x32_bf16 v[196:199], v[148:151], v[60:63], 0
    v_mfma_f32_16x16x32_bf16 v[200:203], v[136:139], v[64:67], 0
    v_mfma_f32_16x16x32_bf16 v[204:207], v[140:143], v[64:67], 0
    v_mfma_f32_16x16x32_bf16 v[208:211], v[144:147], v[64:67], 0
    v_mfma_f32_16x16x32_bf16 v[212:215], v[148:151], v[64:67], 0
    v_mfma_f32_16x16x32_bf16 v[216:219], v[136:139], v[68:71], 0
    v_mfma_f32_16x16x32_bf16 v[220:223], v[140:143], v[68:71], 0
    v_mfma_f32_16x16x32_bf16 v[224:227], v[144:147], v[68:71], 0
    v_mfma_f32_16x16x32_bf16 v[228:231], v[148:151], v[68:71], 0
    v_mfma_f32_16x16x32_bf16 v[232:235], v[136:139], v[72:75], 0
    v_mfma_f32_16x16x32_bf16 v[236:239], v[140:143], v[72:75], 0
    v_mfma_f32_16x16x32_bf16 v[240:243], v[144:147], v[72:75], 0
    v_mfma_f32_16x16x32_bf16 v[244:247], v[148:151], v[72:75], 0
    s_nop 7
    s_nop 7
    s_mov_b32 s40, 0
    buffer_load_dwordx4 v[56:59], v5, s[28:31], s40 offen offset:256
    s_mov_b32 s40, 8192
    buffer_load_dwordx4 v[60:63], v5, s[28:31], s40 offen offset:256
    s_mov_b32 s40, 16384
    buffer_load_dwordx4 v[64:67], v5, s[28:31], s40 offen offset:256
    s_mov_b32 s40, 24576
    buffer_load_dwordx4 v[68:71], v5, s[28:31], s40 offen offset:256
    s_mov_b32 s40, 32768
    buffer_load_dwordx4 v[72:75], v5, s[28:31], s40 offen offset:256
    ds_read_b64_tr_b16 v[136:137], v7 offset:9216
    ds_read_b64_tr_b16 v[138:139], v7 offset:9792
    ds_read_b64_tr_b16 v[140:141], v7 offset:9248
    ds_read_b64_tr_b16 v[142:143], v7 offset:9824
    ds_read_b64_tr_b16 v[144:145], v7 offset:9280
    ds_read_b64_tr_b16 v[146:147], v7 offset:9856
    ds_read_b64_tr_b16 v[148:149], v7 offset:9312
    ds_read_b64_tr_b16 v[150:151], v7 offset:9888
    s_waitcnt vmcnt(20) lgkmcnt(8)
    v_mfma_f32_16x16x32_bf16 v[168:171], v[152:155], v[76:79], v[168:171]
    v_mfma_f32_16x16x32_bf16 v[172:175], v[156:159], v[76:79], v[172:175]
    v_mfma_f32_16x16x32_bf16 v[176:179], v[160:163], v[76:79], v[176:179]
    v_mfma_f32_16x16x32_bf16 v[180:183], v[164:167], v[76:79], v[180:183]
    v_mfma_f32_16x16x32_bf16 v[184:187], v[152:155], v[80:83], v[184:187]
    v_mfma_f32_16x16x32_bf16 v[188:191], v[156:159], v[80:83], v[188:191]
    v_mfma_f32_16x16x32_bf16 v[192:195], v[160:163], v[80:83], v[192:195]
    v_mfma_f32_16x16x32_bf16 v[196:199], v[164:167], v[80:83], v[196:199]
    v_mfma_f32_16x16x32_bf16 v[200:203], v[152:155], v[84:87], v[200:203]
    v_mfma_f32_16x16x32_bf16 v[204:207], v[156:159], v[84:87], v[204:207]
    v_mfma_f32_16x16x32_bf16 v[208:211], v[160:163], v[84:87], v[208:211]
    v_mfma_f32_16x16x32_bf16 v[212:215], v[164:167], v[84:87], v[212:215]
    v_mfma_f32_16x16x32_bf16 v[216:219], v[152:155], v[88:91], v[216:219]
    v_mfma_f32_16x16x32_bf16 v[220:223], v[156:159], v[88:91], v[220:223]
    v_mfma_f32_16x16x32_bf16 v[224:227], v[160:163], v[88:91], v[224:227]
    v_mfma_f32_16x16x32_bf16 v[228:231], v[164:167], v[88:91], v[228:231]
    v_mfma_f32_16x16x32_bf16 v[232:235], v[152:155], v[92:95], v[232:235]
    v_mfma_f32_16x16x32_bf16 v[236:239], v[156:159], v[92:95], v[236:239]
    v_mfma_f32_16x16x32_bf16 v[240:243], v[160:163], v[92:95], v[240:243]
    v_mfma_f32_16x16x32_bf16 v[244:247], v[164:167], v[92:95], v[244:247]
    s_nop 7
    s_nop 7
    s_mov_b32 s40, 0
    buffer_load_dwordx4 v[76:79], v5, s[28:31], s40 offen offset:320
    s_mov_b32 s40, 8192
    buffer_load_dwordx4 v[80:83], v5, s[28:31], s40 offen offset:320
    s_mov_b32 s40, 16384
    buffer_load_dwordx4 v[84:87], v5, s[28:31], s40 offen offset:320
    s_mov_b32 s40, 24576
    buffer_load_dwordx4 v[88:91], v5, s[28:31], s40 offen offset:320
    s_mov_b32 s40, 32768
    buffer_load_dwordx4 v[92:95], v5, s[28:31], s40 offen offset:320
    ds_read_b64_tr_b16 v[152:153], v7 offset:13824
    ds_read_b64_tr_b16 v[154:155], v7 offset:14400
    ds_read_b64_tr_b16 v[156:157], v7 offset:13856
    ds_read_b64_tr_b16 v[158:159], v7 offset:14432
    ds_read_b64_tr_b16 v[160:161], v7 offset:13888
    ds_read_b64_tr_b16 v[162:163], v7 offset:14464
    ds_read_b64_tr_b16 v[164:165], v7 offset:13920
    ds_read_b64_tr_b16 v[166:167], v7 offset:14496
    s_waitcnt vmcnt(20) lgkmcnt(8)
    v_mfma_f32_16x16x32_bf16 v[168:171], v[136:139], v[96:99], v[168:171]
    v_mfma_f32_16x16x32_bf16 v[172:175], v[140:143], v[96:99], v[172:175]
    v_mfma_f32_16x16x32_bf16 v[176:179], v[144:147], v[96:99], v[176:179]
    v_mfma_f32_16x16x32_bf16 v[180:183], v[148:151], v[96:99], v[180:183]
    v_mfma_f32_16x16x32_bf16 v[184:187], v[136:139], v[100:103], v[184:187]
    v_mfma_f32_16x16x32_bf16 v[188:191], v[140:143], v[100:103], v[188:191]
    v_mfma_f32_16x16x32_bf16 v[192:195], v[144:147], v[100:103], v[192:195]
    v_mfma_f32_16x16x32_bf16 v[196:199], v[148:151], v[100:103], v[196:199]
    v_mfma_f32_16x16x32_bf16 v[200:203], v[136:139], v[104:107], v[200:203]
    v_mfma_f32_16x16x32_bf16 v[204:207], v[140:143], v[104:107], v[204:207]
    v_mfma_f32_16x16x32_bf16 v[208:211], v[144:147], v[104:107], v[208:211]
    v_mfma_f32_16x16x32_bf16 v[212:215], v[148:151], v[104:107], v[212:215]
    v_mfma_f32_16x16x32_bf16 v[216:219], v[136:139], v[108:111], v[216:219]
    v_mfma_f32_16x16x32_bf16 v[220:223], v[140:143], v[108:111], v[220:223]
    v_mfma_f32_16x16x32_bf16 v[224:227], v[144:147], v[108:111], v[224:227]
    v_mfma_f32_16x16x32_bf16 v[228:231], v[148:151], v[108:111], v[228:231]
    v_mfma_f32_16x16x32_bf16 v[232:235], v[136:139], v[112:115], v[232:235]
    v_mfma_f32_16x16x32_bf16 v[236:239], v[140:143], v[112:115], v[236:239]
    v_mfma_f32_16x16x32_bf16 v[240:243], v[144:147], v[112:115], v[240:243]
    v_mfma_f32_16x16x32_bf16 v[244:247], v[148:151], v[112:115], v[244:247]
    s_nop 7
    s_nop 7
    s_mov_b32 s40, 0
    buffer_load_dwordx4 v[96:99], v5, s[28:31], s40 offen offset:384
    s_mov_b32 s40, 8192
    buffer_load_dwordx4 v[100:103], v5, s[28:31], s40 offen offset:384
    s_mov_b32 s40, 16384
    buffer_load_dwordx4 v[104:107], v5, s[28:31], s40 offen offset:384
    s_mov_b32 s40, 24576
    buffer_load_dwordx4 v[108:111], v5, s[28:31], s40 offen offset:384
    s_mov_b32 s40, 32768
    buffer_load_dwordx4 v[112:115], v5, s[28:31], s40 offen offset:384
    ds_read_b64_tr_b16 v[136:137], v7 offset:18432
    ds_read_b64_tr_b16 v[138:139], v7 offset:19008
    ds_read_b64_tr_b16 v[140:141], v7 offset:18464
    ds_read_b64_tr_b16 v[142:143], v7 offset:19040
    ds_read_b64_tr_b16 v[144:145], v7 offset:18496
    ds_read_b64_tr_b16 v[146:147], v7 offset:19072
    ds_read_b64_tr_b16 v[148:149], v7 offset:18528
    ds_read_b64_tr_b16 v[150:151], v7 offset:19104
    s_waitcnt vmcnt(20) lgkmcnt(8)
    v_mfma_f32_16x16x32_bf16 v[168:171], v[152:155], v[116:119], v[168:171]
    v_mfma_f32_16x16x32_bf16 v[172:175], v[156:159], v[116:119], v[172:175]
    v_mfma_f32_16x16x32_bf16 v[176:179], v[160:163], v[116:119], v[176:179]
    v_mfma_f32_16x16x32_bf16 v[180:183], v[164:167], v[116:119], v[180:183]
    v_mfma_f32_16x16x32_bf16 v[184:187], v[152:155], v[120:123], v[184:187]
    v_mfma_f32_16x16x32_bf16 v[188:191], v[156:159], v[120:123], v[188:191]
    v_mfma_f32_16x16x32_bf16 v[192:195], v[160:163], v[120:123], v[192:195]
    v_mfma_f32_16x16x32_bf16 v[196:199], v[164:167], v[120:123], v[196:199]
    v_mfma_f32_16x16x32_bf16 v[200:203], v[152:155], v[124:127], v[200:203]
    v_mfma_f32_16x16x32_bf16 v[204:207], v[156:159], v[124:127], v[204:207]
    v_mfma_f32_16x16x32_bf16 v[208:211], v[160:163], v[124:127], v[208:211]
    v_mfma_f32_16x16x32_bf16 v[212:215], v[164:167], v[124:127], v[212:215]
    v_mfma_f32_16x16x32_bf16 v[216:219], v[152:155], v[128:131], v[216:219]
    v_mfma_f32_16x16x32_bf16 v[220:223], v[156:159], v[128:131], v[220:223]
    v_mfma_f32_16x16x32_bf16 v[224:227], v[160:163], v[128:131], v[224:227]
    v_mfma_f32_16x16x32_bf16 v[228:231], v[164:167], v[128:131], v[228:231]
    v_mfma_f32_16x16x32_bf16 v[232:235], v[152:155], v[132:135], v[232:235]
    v_mfma_f32_16x16x32_bf16 v[236:239], v[156:159], v[132:135], v[236:239]
    v_mfma_f32_16x16x32_bf16 v[240:243], v[160:163], v[132:135], v[240:243]
    v_mfma_f32_16x16x32_bf16 v[244:247], v[164:167], v[132:135], v[244:247]
    s_nop 7
    s_nop 7
    s_mov_b32 s40, 0
    buffer_load_dwordx4 v[116:119], v5, s[28:31], s40 offen offset:448
    s_mov_b32 s40, 8192
    buffer_load_dwordx4 v[120:123], v5, s[28:31], s40 offen offset:448
    s_mov_b32 s40, 16384
    buffer_load_dwordx4 v[124:127], v5, s[28:31], s40 offen offset:448
    s_mov_b32 s40, 24576
    buffer_load_dwordx4 v[128:131], v5, s[28:31], s40 offen offset:448
    s_mov_b32 s40, 32768
    buffer_load_dwordx4 v[132:135], v5, s[28:31], s40 offen offset:448
    ds_read_b64_tr_b16 v[152:153], v7 offset:23040
    ds_read_b64_tr_b16 v[154:155], v7 offset:23616
    ds_read_b64_tr_b16 v[156:157], v7 offset:23072
    ds_read_b64_tr_b16 v[158:159], v7 offset:23648
    ds_read_b64_tr_b16 v[160:161], v7 offset:23104
    ds_read_b64_tr_b16 v[162:163], v7 offset:23680
    ds_read_b64_tr_b16 v[164:165], v7 offset:23136
    ds_read_b64_tr_b16 v[166:167], v7 offset:23712
    s_waitcnt vmcnt(15) lgkmcnt(8)
    v_mfma_f32_16x16x32_bf16 v[168:171], v[136:139], v[56:59], v[168:171]
    v_mfma_f32_16x16x32_bf16 v[172:175], v[140:143], v[56:59], v[172:175]
    v_mfma_f32_16x16x32_bf16 v[176:179], v[144:147], v[56:59], v[176:179]
    v_mfma_f32_16x16x32_bf16 v[180:183], v[148:151], v[56:59], v[180:183]
    v_mfma_f32_16x16x32_bf16 v[184:187], v[136:139], v[60:63], v[184:187]
    v_mfma_f32_16x16x32_bf16 v[188:191], v[140:143], v[60:63], v[188:191]
    v_mfma_f32_16x16x32_bf16 v[192:195], v[144:147], v[60:63], v[192:195]
    v_mfma_f32_16x16x32_bf16 v[196:199], v[148:151], v[60:63], v[196:199]
    v_mfma_f32_16x16x32_bf16 v[200:203], v[136:139], v[64:67], v[200:203]
    v_mfma_f32_16x16x32_bf16 v[204:207], v[140:143], v[64:67], v[204:207]
    v_mfma_f32_16x16x32_bf16 v[208:211], v[144:147], v[64:67], v[208:211]
    v_mfma_f32_16x16x32_bf16 v[212:215], v[148:151], v[64:67], v[212:215]
    v_mfma_f32_16x16x32_bf16 v[216:219], v[136:139], v[68:71], v[216:219]
    v_mfma_f32_16x16x32_bf16 v[220:223], v[140:143], v[68:71], v[220:223]
    v_mfma_f32_16x16x32_bf16 v[224:227], v[144:147], v[68:71], v[224:227]
    v_mfma_f32_16x16x32_bf16 v[228:231], v[148:151], v[68:71], v[228:231]
    v_mfma_f32_16x16x32_bf16 v[232:235], v[136:139], v[72:75], v[232:235]
    v_mfma_f32_16x16x32_bf16 v[236:239], v[140:143], v[72:75], v[236:239]
    v_mfma_f32_16x16x32_bf16 v[240:243], v[144:147], v[72:75], v[240:243]
    v_mfma_f32_16x16x32_bf16 v[244:247], v[148:151], v[72:75], v[244:247]
    ds_read_b64_tr_b16 v[136:137], v7 offset:27648
    ds_read_b64_tr_b16 v[138:139], v7 offset:28224
    ds_read_b64_tr_b16 v[140:141], v7 offset:27680
    ds_read_b64_tr_b16 v[142:143], v7 offset:28256
    ds_read_b64_tr_b16 v[144:145], v7 offset:27712
    ds_read_b64_tr_b16 v[146:147], v7 offset:28288
    ds_read_b64_tr_b16 v[148:149], v7 offset:27744
    ds_read_b64_tr_b16 v[150:151], v7 offset:28320
    s_waitcnt vmcnt(10) lgkmcnt(8)
    v_mfma_f32_16x16x32_bf16 v[168:171], v[152:155], v[76:79], v[168:171]
    v_mfma_f32_16x16x32_bf16 v[172:175], v[156:159], v[76:79], v[172:175]
    v_mfma_f32_16x16x32_bf16 v[176:179], v[160:163], v[76:79], v[176:179]
    v_mfma_f32_16x16x32_bf16 v[180:183], v[164:167], v[76:79], v[180:183]
    v_mfma_f32_16x16x32_bf16 v[184:187], v[152:155], v[80:83], v[184:187]
    v_mfma_f32_16x16x32_bf16 v[188:191], v[156:159], v[80:83], v[188:191]
    v_mfma_f32_16x16x32_bf16 v[192:195], v[160:163], v[80:83], v[192:195]
    v_mfma_f32_16x16x32_bf16 v[196:199], v[164:167], v[80:83], v[196:199]
    v_mfma_f32_16x16x32_bf16 v[200:203], v[152:155], v[84:87], v[200:203]
    v_mfma_f32_16x16x32_bf16 v[204:207], v[156:159], v[84:87], v[204:207]
    v_mfma_f32_16x16x32_bf16 v[208:211], v[160:163], v[84:87], v[208:211]
    v_mfma_f32_16x16x32_bf16 v[212:215], v[164:167], v[84:87], v[212:215]
    v_mfma_f32_16x16x32_bf16 v[216:219], v[152:155], v[88:91], v[216:219]
    v_mfma_f32_16x16x32_bf16 v[220:223], v[156:159], v[88:91], v[220:223]
    v_mfma_f32_16x16x32_bf16 v[224:227], v[160:163], v[88:91], v[224:227]
    v_mfma_f32_16x16x32_bf16 v[228:231], v[164:167], v[88:91], v[228:231]
    v_mfma_f32_16x16x32_bf16 v[232:235], v[152:155], v[92:95], v[232:235]
    v_mfma_f32_16x16x32_bf16 v[236:239], v[156:159], v[92:95], v[236:239]
    v_mfma_f32_16x16x32_bf16 v[240:243], v[160:163], v[92:95], v[240:243]
    v_mfma_f32_16x16x32_bf16 v[244:247], v[164:167], v[92:95], v[244:247]
    ds_read_b64_tr_b16 v[152:153], v7 offset:32256
    ds_read_b64_tr_b16 v[154:155], v7 offset:32832
    ds_read_b64_tr_b16 v[156:157], v7 offset:32288
    ds_read_b64_tr_b16 v[158:159], v7 offset:32864
    ds_read_b64_tr_b16 v[160:161], v7 offset:32320
    ds_read_b64_tr_b16 v[162:163], v7 offset:32896
    ds_read_b64_tr_b16 v[164:165], v7 offset:32352
    ds_read_b64_tr_b16 v[166:167], v7 offset:32928
    s_waitcnt vmcnt(5) lgkmcnt(8)
    v_mfma_f32_16x16x32_bf16 v[168:171], v[136:139], v[96:99], v[168:171]
    v_mfma_f32_16x16x32_bf16 v[172:175], v[140:143], v[96:99], v[172:175]
    v_mfma_f32_16x16x32_bf16 v[176:179], v[144:147], v[96:99], v[176:179]
    v_mfma_f32_16x16x32_bf16 v[180:183], v[148:151], v[96:99], v[180:183]
    v_mfma_f32_16x16x32_bf16 v[184:187], v[136:139], v[100:103], v[184:187]
    v_mfma_f32_16x16x32_bf16 v[188:191], v[140:143], v[100:103], v[188:191]
    v_mfma_f32_16x16x32_bf16 v[192:195], v[144:147], v[100:103], v[192:195]
    v_mfma_f32_16x16x32_bf16 v[196:199], v[148:151], v[100:103], v[196:199]
    v_mfma_f32_16x16x32_bf16 v[200:203], v[136:139], v[104:107], v[200:203]
    v_mfma_f32_16x16x32_bf16 v[204:207], v[140:143], v[104:107], v[204:207]
    v_mfma_f32_16x16x32_bf16 v[208:211], v[144:147], v[104:107], v[208:211]
    v_mfma_f32_16x16x32_bf16 v[212:215], v[148:151], v[104:107], v[212:215]
    v_mfma_f32_16x16x32_bf16 v[216:219], v[136:139], v[108:111], v[216:219]
    v_mfma_f32_16x16x32_bf16 v[220:223], v[140:143], v[108:111], v[220:223]
    v_mfma_f32_16x16x32_bf16 v[224:227], v[144:147], v[108:111], v[224:227]
    v_mfma_f32_16x16x32_bf16 v[228:231], v[148:151], v[108:111], v[228:231]
    v_mfma_f32_16x16x32_bf16 v[232:235], v[136:139], v[112:115], v[232:235]
    v_mfma_f32_16x16x32_bf16 v[236:239], v[140:143], v[112:115], v[236:239]
    v_mfma_f32_16x16x32_bf16 v[240:243], v[144:147], v[112:115], v[240:243]
    v_mfma_f32_16x16x32_bf16 v[244:247], v[148:151], v[112:115], v[244:247]
    s_waitcnt vmcnt(0) lgkmcnt(0)
    v_mfma_f32_16x16x32_bf16 v[168:171], v[152:155], v[116:119], v[168:171]
    v_mfma_f32_16x16x32_bf16 v[172:175], v[156:159], v[116:119], v[172:175]
    v_mfma_f32_16x16x32_bf16 v[176:179], v[160:163], v[116:119], v[176:179]
    v_mfma_f32_16x16x32_bf16 v[180:183], v[164:167], v[116:119], v[180:183]
    v_mfma_f32_16x16x32_bf16 v[184:187], v[152:155], v[120:123], v[184:187]
    v_mfma_f32_16x16x32_bf16 v[188:191], v[156:159], v[120:123], v[188:191]
    v_mfma_f32_16x16x32_bf16 v[192:195], v[160:163], v[120:123], v[192:195]
    v_mfma_f32_16x16x32_bf16 v[196:199], v[164:167], v[120:123], v[196:199]
    v_mfma_f32_16x16x32_bf16 v[200:203], v[152:155], v[124:127], v[200:203]
    v_mfma_f32_16x16x32_bf16 v[204:207], v[156:159], v[124:127], v[204:207]
    v_mfma_f32_16x16x32_bf16 v[208:211], v[160:163], v[124:127], v[208:211]
    v_mfma_f32_16x16x32_bf16 v[212:215], v[164:167], v[124:127], v[212:215]
    v_mfma_f32_16x16x32_bf16 v[216:219], v[152:155], v[128:131], v[216:219]
    v_mfma_f32_16x16x32_bf16 v[220:223], v[156:159], v[128:131], v[220:223]
    v_mfma_f32_16x16x32_bf16 v[224:227], v[160:163], v[128:131], v[224:227]
    v_mfma_f32_16x16x32_bf16 v[228:231], v[164:167], v[128:131], v[228:231]
    v_mfma_f32_16x16x32_bf16 v[232:235], v[152:155], v[132:135], v[232:235]
    v_mfma_f32_16x16x32_bf16 v[236:239], v[156:159], v[132:135], v[236:239]
    v_mfma_f32_16x16x32_bf16 v[240:243], v[160:163], v[132:135], v[240:243]
    v_mfma_f32_16x16x32_bf16 v[244:247], v[164:167], v[132:135], v[244:247]
    s_nop 7
    s_nop 7
    v_and_b32 v9, 15, v0
    s_cmp_eq_u32 s37, 1
    s_cbranch_scc1 k1_epi_b
    s_lshl_b32 s40, s3, 6
    s_add_u32 s40, s40, 0
    v_lshlrev_b32 v10, 2, v6
    v_add_u32 v10, s40, v10
    v_lshrrev_b32 v11, 7, v10
    v_lshlrev_b32 v11, 1, v11
    v_bfe_u32 v12, v10, 2, 1
    v_or_b32 v11, v11, v12
    v_lshlrev_b32 v11, 8, v11
    v_bfe_u32 v12, v10, 3, 4
    v_lshlrev_b32 v12, 4, v12
    v_add_u32 v11, v11, v12
    v_lshlrev_b32 v12, 10, v9
    v_add_u32 v11, v11, v12
    v_mul_f32 v168, 0xbfb8aa3b, v168
    v_mul_f32 v169, 0xbfb8aa3b, v169
    v_mul_f32 v170, 0xbfb8aa3b, v170
    v_mul_f32 v171, 0xbfb8aa3b, v171
    s_mul_i32 s40, s36, 81920
    s_add_u32 s40, s40, 0
    buffer_store_dwordx4 v[168:171], v11, s[24:27], s40 offen
    v_mul_f32 v184, 0xbfb8aa3b, v184
    v_mul_f32 v185, 0xbfb8aa3b, v185
    v_mul_f32 v186, 0xbfb8aa3b, v186
    v_mul_f32 v187, 0xbfb8aa3b, v187
    s_mul_i32 s40, s36, 81920
    s_add_u32 s40, s40, 16384
    buffer_store_dwordx4 v[184:187], v11, s[24:27], s40 offen
    v_mul_f32 v200, 0xbfb8aa3b, v200
    v_mul_f32 v201, 0xbfb8aa3b, v201
    v_mul_f32 v202, 0xbfb8aa3b, v202
    v_mul_f32 v203, 0xbfb8aa3b, v203
    s_mul_i32 s40, s36, 81920
    s_add_u32 s40, s40, 32768
    buffer_store_dwordx4 v[200:203], v11, s[24:27], s40 offen
    v_mul_f32 v216, 0xbfb8aa3b, v216
    v_mul_f32 v217, 0xbfb8aa3b, v217
    v_mul_f32 v218, 0xbfb8aa3b, v218
    v_mul_f32 v219, 0xbfb8aa3b, v219
    s_mul_i32 s40, s36, 81920
    s_add_u32 s40, s40, 49152
    buffer_store_dwordx4 v[216:219], v11, s[24:27], s40 offen
    v_mul_f32 v232, 0xbfb8aa3b, v232
    v_mul_f32 v233, 0xbfb8aa3b, v233
    v_mul_f32 v234, 0xbfb8aa3b, v234
    v_mul_f32 v235, 0xbfb8aa3b, v235
    s_mul_i32 s40, s36, 81920
    s_add_u32 s40, s40, 65536
    buffer_store_dwordx4 v[232:235], v11, s[24:27], s40 offen
    s_lshl_b32 s40, s3, 6
    s_add_u32 s40, s40, 16
    v_lshlrev_b32 v10, 2, v6
    v_add_u32 v10, s40, v10
    v_lshrrev_b32 v11, 7, v10
    v_lshlrev_b32 v11, 1, v11
    v_bfe_u32 v12, v10, 2, 1
    v_or_b32 v11, v11, v12
    v_lshlrev_b32 v11, 8, v11
    v_bfe_u32 v12, v10, 3, 4
    v_lshlrev_b32 v12, 4, v12
    v_add_u32 v11, v11, v12
    v_lshlrev_b32 v12, 10, v9
    v_add_u32 v11, v11, v12
    v_mul_f32 v172, 0xbfb8aa3b, v172
    v_mul_f32 v173, 0xbfb8aa3b, v173
    v_mul_f32 v174, 0xbfb8aa3b, v174
    v_mul_f32 v175, 0xbfb8aa3b, v175
    s_mul_i32 s40, s36, 81920
    s_add_u32 s40, s40, 0
    buffer_store_dwordx4 v[172:175], v11, s[24:27], s40 offen
    v_mul_f32 v188, 0xbfb8aa3b, v188
    v_mul_f32 v189, 0xbfb8aa3b, v189
    v_mul_f32 v190, 0xbfb8aa3b, v190
    v_mul_f32 v191, 0xbfb8aa3b, v191
    s_mul_i32 s40, s36, 81920
    s_add_u32 s40, s40, 16384
    buffer_store_dwordx4 v[188:191], v11, s[24:27], s40 offen
    v_mul_f32 v204, 0xbfb8aa3b, v204
    v_mul_f32 v205, 0xbfb8aa3b, v205
    v_mul_f32 v206, 0xbfb8aa3b, v206
    v_mul_f32 v207, 0xbfb8aa3b, v207
    s_mul_i32 s40, s36, 81920
    s_add_u32 s40, s40, 32768
    buffer_store_dwordx4 v[204:207], v11, s[24:27], s40 offen
    v_mul_f32 v220, 0xbfb8aa3b, v220
    v_mul_f32 v221, 0xbfb8aa3b, v221
    v_mul_f32 v222, 0xbfb8aa3b, v222
    v_mul_f32 v223, 0xbfb8aa3b, v223
    s_mul_i32 s40, s36, 81920
    s_add_u32 s40, s40, 49152
    buffer_store_dwordx4 v[220:223], v11, s[24:27], s40 offen
    v_mul_f32 v236, 0xbfb8aa3b, v236
    v_mul_f32 v237, 0xbfb8aa3b, v237
    v_mul_f32 v238, 0xbfb8aa3b, v238
    v_mul_f32 v239, 0xbfb8aa3b, v239
    s_mul_i32 s40, s36, 81920
    s_add_u32 s40, s40, 65536
    buffer_store_dwordx4 v[236:239], v11, s[24:27], s40 offen
    s_lshl_b32 s40, s3, 6
    s_add_u32 s40, s40, 32
    v_lshlrev_b32 v10, 2, v6
    v_add_u32 v10, s40, v10
    v_lshrrev_b32 v11, 7, v10
    v_lshlrev_b32 v11, 1, v11
    v_bfe_u32 v12, v10, 2, 1
    v_or_b32 v11, v11, v12
    v_lshlrev_b32 v11, 8, v11
    v_bfe_u32 v12, v10, 3, 4
    v_lshlrev_b32 v12, 4, v12
    v_add_u32 v11, v11, v12
    v_lshlrev_b32 v12, 10, v9
    v_add_u32 v11, v11, v12
    v_mul_f32 v176, 0xbfb8aa3b, v176
    v_mul_f32 v177, 0xbfb8aa3b, v177
    v_mul_f32 v178, 0xbfb8aa3b, v178
    v_mul_f32 v179, 0xbfb8aa3b, v179
    s_mul_i32 s40, s36, 81920
    s_add_u32 s40, s40, 0
    buffer_store_dwordx4 v[176:179], v11, s[24:27], s40 offen
    v_mul_f32 v192, 0xbfb8aa3b, v192
    v_mul_f32 v193, 0xbfb8aa3b, v193
    v_mul_f32 v194, 0xbfb8aa3b, v194
    v_mul_f32 v195, 0xbfb8aa3b, v195
    s_mul_i32 s40, s36, 81920
    s_add_u32 s40, s40, 16384
    buffer_store_dwordx4 v[192:195], v11, s[24:27], s40 offen
    v_mul_f32 v208, 0xbfb8aa3b, v208
    v_mul_f32 v209, 0xbfb8aa3b, v209
    v_mul_f32 v210, 0xbfb8aa3b, v210
    v_mul_f32 v211, 0xbfb8aa3b, v211
    s_mul_i32 s40, s36, 81920
    s_add_u32 s40, s40, 32768
    buffer_store_dwordx4 v[208:211], v11, s[24:27], s40 offen
    v_mul_f32 v224, 0xbfb8aa3b, v224
    v_mul_f32 v225, 0xbfb8aa3b, v225
    v_mul_f32 v226, 0xbfb8aa3b, v226
    v_mul_f32 v227, 0xbfb8aa3b, v227
    s_mul_i32 s40, s36, 81920
    s_add_u32 s40, s40, 49152
    buffer_store_dwordx4 v[224:227], v11, s[24:27], s40 offen
    v_mul_f32 v240, 0xbfb8aa3b, v240
    v_mul_f32 v241, 0xbfb8aa3b, v241
    v_mul_f32 v242, 0xbfb8aa3b, v242
    v_mul_f32 v243, 0xbfb8aa3b, v243
    s_mul_i32 s40, s36, 81920
    s_add_u32 s40, s40, 65536
    buffer_store_dwordx4 v[240:243], v11, s[24:27], s40 offen
    s_lshl_b32 s40, s3, 6
    s_add_u32 s40, s40, 48
    v_lshlrev_b32 v10, 2, v6
    v_add_u32 v10, s40, v10
    v_lshrrev_b32 v11, 7, v10
    v_lshlrev_b32 v11, 1, v11
    v_bfe_u32 v12, v10, 2, 1
    v_or_b32 v11, v11, v12
    v_lshlrev_b32 v11, 8, v11
    v_bfe_u32 v12, v10, 3, 4
    v_lshlrev_b32 v12, 4, v12
    v_add_u32 v11, v11, v12
    v_lshlrev_b32 v12, 10, v9
    v_add_u32 v11, v11, v12
    v_mul_f32 v180, 0xbfb8aa3b, v180
    v_mul_f32 v181, 0xbfb8aa3b, v181
    v_mul_f32 v182, 0xbfb8aa3b, v182
    v_mul_f32 v183, 0xbfb8aa3b, v183
    s_mul_i32 s40, s36, 81920
    s_add_u32 s40, s40, 0
    buffer_store_dwordx4 v[180:183], v11, s[24:27], s40 offen
    v_mul_f32 v196, 0xbfb8aa3b, v196
    v_mul_f32 v197, 0xbfb8aa3b, v197
    v_mul_f32 v198, 0xbfb8aa3b, v198
    v_mul_f32 v199, 0xbfb8aa3b, v199
    s_mul_i32 s40, s36, 81920
    s_add_u32 s40, s40, 16384
    buffer_store_dwordx4 v[196:199], v11, s[24:27], s40 offen
    v_mul_f32 v212, 0xbfb8aa3b, v212
    v_mul_f32 v213, 0xbfb8aa3b, v213
    v_mul_f32 v214, 0xbfb8aa3b, v214
    v_mul_f32 v215, 0xbfb8aa3b, v215
    s_mul_i32 s40, s36, 81920
    s_add_u32 s40, s40, 32768
    buffer_store_dwordx4 v[212:215], v11, s[24:27], s40 offen
    v_mul_f32 v228, 0xbfb8aa3b, v228
    v_mul_f32 v229, 0xbfb8aa3b, v229
    v_mul_f32 v230, 0xbfb8aa3b, v230
    v_mul_f32 v231, 0xbfb8aa3b, v231
    s_mul_i32 s40, s36, 81920
    s_add_u32 s40, s40, 49152
    buffer_store_dwordx4 v[228:231], v11, s[24:27], s40 offen
    v_mul_f32 v244, 0xbfb8aa3b, v244
    v_mul_f32 v245, 0xbfb8aa3b, v245
    v_mul_f32 v246, 0xbfb8aa3b, v246
    v_mul_f32 v247, 0xbfb8aa3b, v247
    s_mul_i32 s40, s36, 81920
    s_add_u32 s40, s40, 65536
    buffer_store_dwordx4 v[244:247], v11, s[24:27], s40 offen
    s_cmp_lg_u32 s3, 0
    s_cbranch_scc1 k1_end
    s_branch k1_end
k1_epi_b:
    s_lshl_b32 s40, s3, 6
    s_add_u32 s40, s40, 0
    v_lshlrev_b32 v10, 2, v6
    v_add_u32 v10, s40, v10
    v_lshlrev_b32 v11, 1, v10
    v_lshlrev_b32 v12, 9, v9
    v_add_u32 v11, v11, v12
    v_mul_f32 v168, 0xbfb8aa3b, v168
    v_mul_f32 v169, 0xbfb8aa3b, v169
    v_mul_f32 v170, 0xbfb8aa3b, v170
    v_mul_f32 v171, 0xbfb8aa3b, v171
    v_cvt_pk_bf16_f32 v168, v168, v169
    v_cvt_pk_bf16_f32 v169, v170, v171
    s_mul_i32 s40, s36, 40960
    s_add_u32 s40, s40, 10240000
    buffer_store_dwordx2 v[168:169], v11, s[24:27], s40 offen
    v_mul_f32 v184, 0xbfb8aa3b, v184
    v_mul_f32 v185, 0xbfb8aa3b, v185
    v_mul_f32 v186, 0xbfb8aa3b, v186
    v_mul_f32 v187, 0xbfb8aa3b, v187
    v_cvt_pk_bf16_f32 v184, v184, v185
    v_cvt_pk_bf16_f32 v185, v186, v187
    s_mul_i32 s40, s36, 40960
    s_add_u32 s40, s40, 10248192
    buffer_store_dwordx2 v[184:185], v11, s[24:27], s40 offen
    v_mul_f32 v200, 0xbfb8aa3b, v200
    v_mul_f32 v201, 0xbfb8aa3b, v201
    v_mul_f32 v202, 0xbfb8aa3b, v202
    v_mul_f32 v203, 0xbfb8aa3b, v203
    v_cvt_pk_bf16_f32 v200, v200, v201
    v_cvt_pk_bf16_f32 v201, v202, v203
    s_mul_i32 s40, s36, 40960
    s_add_u32 s40, s40, 10256384
    buffer_store_dwordx2 v[200:201], v11, s[24:27], s40 offen
    v_mul_f32 v216, 0xbfb8aa3b, v216
    v_mul_f32 v217, 0xbfb8aa3b, v217
    v_mul_f32 v218, 0xbfb8aa3b, v218
    v_mul_f32 v219, 0xbfb8aa3b, v219
    v_cvt_pk_bf16_f32 v216, v216, v217
    v_cvt_pk_bf16_f32 v217, v218, v219
    s_mul_i32 s40, s36, 40960
    s_add_u32 s40, s40, 10264576
    buffer_store_dwordx2 v[216:217], v11, s[24:27], s40 offen
    v_mul_f32 v232, 0xbfb8aa3b, v232
    v_mul_f32 v233, 0xbfb8aa3b, v233
    v_mul_f32 v234, 0xbfb8aa3b, v234
    v_mul_f32 v235, 0xbfb8aa3b, v235
    v_cvt_pk_bf16_f32 v232, v232, v233
    v_cvt_pk_bf16_f32 v233, v234, v235
    s_mul_i32 s40, s36, 40960
    s_add_u32 s40, s40, 10272768
    buffer_store_dwordx2 v[232:233], v11, s[24:27], s40 offen
    s_lshl_b32 s40, s3, 6
    s_add_u32 s40, s40, 16
    v_lshlrev_b32 v10, 2, v6
    v_add_u32 v10, s40, v10
    v_lshlrev_b32 v11, 1, v10
    v_lshlrev_b32 v12, 9, v9
    v_add_u32 v11, v11, v12
    v_mul_f32 v172, 0xbfb8aa3b, v172
    v_mul_f32 v173, 0xbfb8aa3b, v173
    v_mul_f32 v174, 0xbfb8aa3b, v174
    v_mul_f32 v175, 0xbfb8aa3b, v175
    v_cvt_pk_bf16_f32 v172, v172, v173
    v_cvt_pk_bf16_f32 v173, v174, v175
    s_mul_i32 s40, s36, 40960
    s_add_u32 s40, s40, 10240000
    buffer_store_dwordx2 v[172:173], v11, s[24:27], s40 offen
    v_mul_f32 v188, 0xbfb8aa3b, v188
    v_mul_f32 v189, 0xbfb8aa3b, v189
    v_mul_f32 v190, 0xbfb8aa3b, v190
    v_mul_f32 v191, 0xbfb8aa3b, v191
    v_cvt_pk_bf16_f32 v188, v188, v189
    v_cvt_pk_bf16_f32 v189, v190, v191
    s_mul_i32 s40, s36, 40960
    s_add_u32 s40, s40, 10248192
    buffer_store_dwordx2 v[188:189], v11, s[24:27], s40 offen
    v_mul_f32 v204, 0xbfb8aa3b, v204
    v_mul_f32 v205, 0xbfb8aa3b, v205
    v_mul_f32 v206, 0xbfb8aa3b, v206
    v_mul_f32 v207, 0xbfb8aa3b, v207
    v_cvt_pk_bf16_f32 v204, v204, v205
    v_cvt_pk_bf16_f32 v205, v206, v207
    s_mul_i32 s40, s36, 40960
    s_add_u32 s40, s40, 10256384
    buffer_store_dwordx2 v[204:205], v11, s[24:27], s40 offen
    v_mul_f32 v220, 0xbfb8aa3b, v220
    v_mul_f32 v221, 0xbfb8aa3b, v221
    v_mul_f32 v222, 0xbfb8aa3b, v222
    v_mul_f32 v223, 0xbfb8aa3b, v223
    v_cvt_pk_bf16_f32 v220, v220, v221
    v_cvt_pk_bf16_f32 v221, v222, v223
    s_mul_i32 s40, s36, 40960
    s_add_u32 s40, s40, 10264576
    buffer_store_dwordx2 v[220:221], v11, s[24:27], s40 offen
    v_mul_f32 v236, 0xbfb8aa3b, v236
    v_mul_f32 v237, 0xbfb8aa3b, v237
    v_mul_f32 v238, 0xbfb8aa3b, v238
    v_mul_f32 v239, 0xbfb8aa3b, v239
    v_cvt_pk_bf16_f32 v236, v236, v237
    v_cvt_pk_bf16_f32 v237, v238, v239
    s_mul_i32 s40, s36, 40960
    s_add_u32 s40, s40, 10272768
    buffer_store_dwordx2 v[236:237], v11, s[24:27], s40 offen
    s_lshl_b32 s40, s3, 6
    s_add_u32 s40, s40, 32
    v_lshlrev_b32 v10, 2, v6
    v_add_u32 v10, s40, v10
    v_lshlrev_b32 v11, 1, v10
    v_lshlrev_b32 v12, 9, v9
    v_add_u32 v11, v11, v12
    v_mul_f32 v176, 0xbfb8aa3b, v176
    v_mul_f32 v177, 0xbfb8aa3b, v177
    v_mul_f32 v178, 0xbfb8aa3b, v178
    v_mul_f32 v179, 0xbfb8aa3b, v179
    v_cvt_pk_bf16_f32 v176, v176, v177
    v_cvt_pk_bf16_f32 v177, v178, v179
    s_mul_i32 s40, s36, 40960
    s_add_u32 s40, s40, 10240000
    buffer_store_dwordx2 v[176:177], v11, s[24:27], s40 offen
    v_mul_f32 v192, 0xbfb8aa3b, v192
    v_mul_f32 v193, 0xbfb8aa3b, v193
    v_mul_f32 v194, 0xbfb8aa3b, v194
    v_mul_f32 v195, 0xbfb8aa3b, v195
    v_cvt_pk_bf16_f32 v192, v192, v193
    v_cvt_pk_bf16_f32 v193, v194, v195
    s_mul_i32 s40, s36, 40960
    s_add_u32 s40, s40, 10248192
    buffer_store_dwordx2 v[192:193], v11, s[24:27], s40 offen
    v_mul_f32 v208, 0xbfb8aa3b, v208
    v_mul_f32 v209, 0xbfb8aa3b, v209
    v_mul_f32 v210, 0xbfb8aa3b, v210
    v_mul_f32 v211, 0xbfb8aa3b, v211
    v_cvt_pk_bf16_f32 v208, v208, v209
    v_cvt_pk_bf16_f32 v209, v210, v211
    s_mul_i32 s40, s36, 40960
    s_add_u32 s40, s40, 10256384
    buffer_store_dwordx2 v[208:209], v11, s[24:27], s40 offen
    v_mul_f32 v224, 0xbfb8aa3b, v224
    v_mul_f32 v225, 0xbfb8aa3b, v225
    v_mul_f32 v226, 0xbfb8aa3b, v226
    v_mul_f32 v227, 0xbfb8aa3b, v227
    v_cvt_pk_bf16_f32 v224, v224, v225
    v_cvt_pk_bf16_f32 v225, v226, v227
    s_mul_i32 s40, s36, 40960
    s_add_u32 s40, s40, 10264576
    buffer_store_dwordx2 v[224:225], v11, s[24:27], s40 offen
    v_mul_f32 v240, 0xbfb8aa3b, v240
    v_mul_f32 v241, 0xbfb8aa3b, v241
    v_mul_f32 v242, 0xbfb8aa3b, v242
    v_mul_f32 v243, 0xbfb8aa3b, v243
    v_cvt_pk_bf16_f32 v240, v240, v241
    v_cvt_pk_bf16_f32 v241, v242, v243
    s_mul_i32 s40, s36, 40960
    s_add_u32 s40, s40, 10272768
    buffer_store_dwordx2 v[240:241], v11, s[24:27], s40 offen
    s_lshl_b32 s40, s3, 6
    s_add_u32 s40, s40, 48
    v_lshlrev_b32 v10, 2, v6
    v_add_u32 v10, s40, v10
    v_lshlrev_b32 v11, 1, v10
    v_lshlrev_b32 v12, 9, v9
    v_add_u32 v11, v11, v12
    v_mul_f32 v180, 0xbfb8aa3b, v180
    v_mul_f32 v181, 0xbfb8aa3b, v181
    v_mul_f32 v182, 0xbfb8aa3b, v182
    v_mul_f32 v183, 0xbfb8aa3b, v183
    v_cvt_pk_bf16_f32 v180, v180, v181
    v_cvt_pk_bf16_f32 v181, v182, v183
    s_mul_i32 s40, s36, 40960
    s_add_u32 s40, s40, 10240000
    buffer_store_dwordx2 v[180:181], v11, s[24:27], s40 offen
    v_mul_f32 v196, 0xbfb8aa3b, v196
    v_mul_f32 v197, 0xbfb8aa3b, v197
    v_mul_f32 v198, 0xbfb8aa3b, v198
    v_mul_f32 v199, 0xbfb8aa3b, v199
    v_cvt_pk_bf16_f32 v196, v196, v197
    v_cvt_pk_bf16_f32 v197, v198, v199
    s_mul_i32 s40, s36, 40960
    s_add_u32 s40, s40, 10248192
    buffer_store_dwordx2 v[196:197], v11, s[24:27], s40 offen
    v_mul_f32 v212, 0xbfb8aa3b, v212
    v_mul_f32 v213, 0xbfb8aa3b, v213
    v_mul_f32 v214, 0xbfb8aa3b, v214
    v_mul_f32 v215, 0xbfb8aa3b, v215
    v_cvt_pk_bf16_f32 v212, v212, v213
    v_cvt_pk_bf16_f32 v213, v214, v215
    s_mul_i32 s40, s36, 40960
    s_add_u32 s40, s40, 10256384
    buffer_store_dwordx2 v[212:213], v11, s[24:27], s40 offen
    v_mul_f32 v228, 0xbfb8aa3b, v228
    v_mul_f32 v229, 0xbfb8aa3b, v229
    v_mul_f32 v230, 0xbfb8aa3b, v230
    v_mul_f32 v231, 0xbfb8aa3b, v231
    v_cvt_pk_bf16_f32 v228, v228, v229
    v_cvt_pk_bf16_f32 v229, v230, v231
    s_mul_i32 s40, s36, 40960
    s_add_u32 s40, s40, 10264576
    buffer_store_dwordx2 v[228:229], v11, s[24:27], s40 offen
    v_mul_f32 v244, 0xbfb8aa3b, v244
    v_mul_f32 v245, 0xbfb8aa3b, v245
    v_mul_f32 v246, 0xbfb8aa3b, v246
    v_mul_f32 v247, 0xbfb8aa3b, v247
    v_cvt_pk_bf16_f32 v244, v244, v245
    v_cvt_pk_bf16_f32 v245, v246, v247
    s_mul_i32 s40, s36, 40960
    s_add_u32 s40, s40, 10272768
    buffer_store_dwordx2 v[244:245], v11, s[24:27], s40 offen
    s_branch k1_end
k1_sort:
    s_mov_b32 s28, s12
    s_mov_b32 s29, s13
    s_mov_b32 s30, 640000
    s_mov_b32 s31, 0x00020000
    s_mov_b32 s32, s10
    s_mov_b32 s33, s11
    s_mov_b32 s34, 640000
    s_mov_b32 s35, 0x00020000
    s_mov_b32 s36, s8
    s_mov_b32 s37, s9
    s_mov_b32 s38, 320000
    s_mov_b32 s39, 0x00020000
    s_mov_b32 s40, s6
    s_mov_b32 s41, s7
    s_mov_b32 s42, 60000
    s_mov_b32 s43, 0x00020000
    s_mov_b32 s44, s18
    s_mov_b32 s45, s19
    s_mov_b32 s46, 262144
    s_mov_b32 s47, 0x00020000
    s_sub_u32 s48, s3, 4
    s_lshl_b32 s49, s2, 2
    s_add_u32 s49, s49, s48
    s_mul_i32 s50, s49, 640
    s_mul_i32 s51, s49, 320
    s_lshl_b32 s52, s48, 10
    s_add_u32 s52, s52, 147456
    v_lshlrev_b32 v19, 2, v0
    v_lshlrev_b32 v32, 1, v0
    buffer_load_dword v1, v19, s[28:31], s50 offen offset:0
    buffer_load_dword v4, v19, s[32:35], s50 offen offset:0
    buffer_load_ushort v7, v32, s[36:39], s51 offen offset:0
    buffer_load_dword v2, v19, s[28:31], s50 offen offset:256
    buffer_load_dword v5, v19, s[32:35], s50 offen offset:256
    buffer_load_ushort v8, v32, s[36:39], s51 offen offset:128
    buffer_load_dword v3, v19, s[28:31], s50 offen offset:512
    buffer_load_dword v6, v19, s[32:35], s50 offen offset:512
    buffer_load_ushort v9, v32, s[36:39], s51 offen offset:256
    v_mov_b32 v36, 0
    v_mov_b32 v37, 0
    v_mov_b32 v38, 0
    v_mov_b32 v39, 0
    v_lshlrev_b32 v40, 4, v0
    v_add_u32 v40, s52, v40
    ds_write_b128 v40, v[36:39]
    s_mov_b32 s53, 52429
    s_waitcnt vmcnt(0)
    v_mul_u32_u24 v10, s53, v1
    v_lshrrev_b32 v10, 21, v10
    v_mul_u32_u24 v13, 40, v10
    v_sub_u32 v13, v1, v13
    v_mul_u32_u24 v41, 6, v1
    v_and_b32 v41, -4, v41
    buffer_load_dwordx2 v[20:21], v41, s[40:43], 0 offen
    v_mul_u32_u24 v41, 6, v4
    v_and_b32 v41, -4, v41
    buffer_load_dwordx2 v[22:23], v41, s[40:43], 0 offen
    v_mul_u32_u24 v11, s53, v2
    v_lshrrev_b32 v11, 21, v11
    v_mul_u32_u24 v14, 40, v11
    v_sub_u32 v14, v2, v14
    v_mul_u32_u24 v41, 6, v2
    v_and_b32 v41, -4, v41
    buffer_load_dwordx2 v[24:25], v41, s[40:43], 0 offen
    v_mul_u32_u24 v41, 6, v5
    v_and_b32 v41, -4, v41
    buffer_load_dwordx2 v[26:27], v41, s[40:43], 0 offen
    v_mul_u32_u24 v12, s53, v3
    v_lshrrev_b32 v12, 21, v12
    v_mul_u32_u24 v15, 40, v12
    v_sub_u32 v15, v3, v15
    v_mul_u32_u24 v41, 6, v3
    v_and_b32 v41, -4, v41
    buffer_load_dwordx2 v[28:29], v41, s[40:43], 0 offen
    v_mul_u32_u24 v41, 6, v6
    v_and_b32 v41, -4, v41
    buffer_load_dwordx2 v[30:31], v41, s[40:43], 0 offen
    s_waitcnt lgkmcnt(0)
    v_mov_b32 v41, 1
    v_lshlrev_b32 v42, 2, v10
    v_add_u32 v42, s52, v42
    ds_add_rtn_u32 v16, v42, v41
    v_lshlrev_b32 v42, 2, v11
    v_add_u32 v42, s52, v42
    ds_add_rtn_u32 v17, v42, v41
    v_lshlrev_b32 v42, 2, v12
    v_add_u32 v42, s52, v42
    v_cmp_gt_u32 vcc, 32, v0
    s_and_saveexec_b64 s[54:55], vcc
    ds_add_rtn_u32 v18, v42, v41
    s_mov_b64 exec, s[54:55]
    s_waitcnt vmcnt(0) lgkmcnt(0)
    ds_read_b128 v[44:47], v40
    v_and_b32 v38, 1, v1
    v_lshlrev_b32 v38, 4, v38
    v_lshrrev_b64 v[20:21], v38, v[20:21]
    v_and_b32 v38, 1, v4
    v_lshlrev_b32 v38, 4, v38
    v_lshrrev_b64 v[22:23], v38, v[22:23]
    v_lshlrev_b32 v32, 16, v20
    v_and_b32 v33, 0xffff0000, v20
    v_lshlrev_b32 v34, 16, v21
    v_lshlrev_b32 v35, 16, v22
    v_and_b32 v36, 0xffff0000, v22
    v_lshlrev_b32 v37, 16, v23
    v_sub_f32 v32, v32, v35
    v_sub_f32 v33, v33, v36
    v_sub_f32 v34, v34, v37
    v_cvt_pk_bf16_f32 v35, v32, v33
    v_cvt_pk_bf16_f32 v36, v34, v34
    v_lshlrev_b32 v52, 16, v35
    v_and_b32 v53, 0xffff0000, v35
    v_lshlrev_b32 v54, 16, v36
    v_mul_f32 v32, v52, v52
    v_mul_f32 v33, v53, v53
    v_mul_f32 v34, v54, v54
    v_cvt_pk_bf16_f32 v35, v32, v33
    v_cvt_pk_bf16_f32 v36, v34, v34
    v_lshlrev_b32 v32, 16, v35
    v_and_b32 v33, 0xffff0000, v35
    v_lshlrev_b32 v34, 16, v36
    v_add_f32 v32, v32, v33
    v_add_f32 v32, v32, v34
    v_cvt_pk_bf16_f32 v35, v32, v32
    v_lshlrev_b32 v49, 16, v35
    v_lshlrev_b32 v48, 9, v4
    v_lshlrev_b32 v50, 16, v7
    v_lshlrev_b32 v51, 10, v13
    v_mov_b32 v55, 0
    v_and_b32 v38, 1, v2
    v_lshlrev_b32 v38, 4, v38
    v_lshrrev_b64 v[24:25], v38, v[24:25]
    v_and_b32 v38, 1, v5
    v_lshlrev_b32 v38, 4, v38
    v_lshrrev_b64 v[26:27], v38, v[26:27]
    v_lshlrev_b32 v32, 16, v24
    v_and_b32 v33, 0xffff0000, v24
    v_lshlrev_b32 v34, 16, v25
    v_lshlrev_b32 v35, 16, v26
    v_and_b32 v36, 0xffff0000, v26
    v_lshlrev_b32 v37, 16, v27
    v_sub_f32 v32, v32, v35
    v_sub_f32 v33, v33, v36
    v_sub_f32 v34, v34, v37
    v_cvt_pk_bf16_f32 v35, v32, v33
    v_cvt_pk_bf16_f32 v36, v34, v34
    v_lshlrev_b32 v60, 16, v35
    v_and_b32 v61, 0xffff0000, v35
    v_lshlrev_b32 v62, 16, v36
    v_mul_f32 v32, v60, v60
    v_mul_f32 v33, v61, v61
    v_mul_f32 v34, v62, v62
    v_cvt_pk_bf16_f32 v35, v32, v33
    v_cvt_pk_bf16_f32 v36, v34, v34
    v_lshlrev_b32 v32, 16, v35
    v_and_b32 v33, 0xffff0000, v35
    v_lshlrev_b32 v34, 16, v36
    v_add_f32 v32, v32, v33
    v_add_f32 v32, v32, v34
    v_cvt_pk_bf16_f32 v35, v32, v32
    v_lshlrev_b32 v57, 16, v35
    v_lshlrev_b32 v56, 9, v5
    v_lshlrev_b32 v58, 16, v8
    v_lshlrev_b32 v59, 10, v14
    v_mov_b32 v63, 0
    v_and_b32 v38, 1, v3
    v_lshlrev_b32 v38, 4, v38
    v_lshrrev_b64 v[28:29], v38, v[28:29]
    v_and_b32 v38, 1, v6
    v_lshlrev_b32 v38, 4, v38
    v_lshrrev_b64 v[30:31], v38, v[30:31]
    v_lshlrev_b32 v32, 16, v28
    v_and_b32 v33, 0xffff0000, v28
    v_lshlrev_b32 v34, 16, v29
    v_lshlrev_b32 v35, 16, v30
    v_and_b32 v36, 0xffff0000, v30
    v_lshlrev_b32 v37, 16, v31
    v_sub_f32 v32, v32, v35
    v_sub_f32 v33, v33, v36
    v_sub_f32 v34, v34, v37
    v_cvt_pk_bf16_f32 v35, v32, v33
    v_cvt_pk_bf16_f32 v36, v34, v34
    v_lshlrev_b32 v68, 16, v35
    v_and_b32 v69, 0xffff0000, v35
    v_lshlrev_b32 v70, 16, v36
    v_mul_f32 v32, v68, v68
    v_mul_f32 v33, v69, v69
    v_mul_f32 v34, v70, v70
    v_cvt_pk_bf16_f32 v35, v32, v33
    v_cvt_pk_bf16_f32 v36, v34, v34
    v_lshlrev_b32 v32, 16, v35
    v_and_b32 v33, 0xffff0000, v35
    v_lshlrev_b32 v34, 16, v36
    v_add_f32 v32, v32, v33
    v_add_f32 v32, v32, v34
    v_cvt_pk_bf16_f32 v35, v32, v32
    v_lshlrev_b32 v65, 16, v35
    v_lshlrev_b32 v64, 9, v6
    v_lshlrev_b32 v66, 16, v9
    v_lshlrev_b32 v67, 10, v15
    v_mov_b32 v71, 0
    s_waitcnt lgkmcnt(0)
    v_add_u32 v45, v44, v45
    v_add_u32 v46, v45, v46
    v_add_u32 v38, v46, v47
    v_mov_b32 v39, v38
    s_nop 1
    v_add_u32_dpp v39, v39, v39 row_shr:1 row_mask:0xf bank_mask:0xf bound_ctrl:0
    s_nop 1
    v_add_u32_dpp v39, v39, v39 row_shr:2 row_mask:0xf bank_mask:0xf bound_ctrl:0
    s_nop 1
    v_add_u32_dpp v39, v39, v39 row_shr:4 row_mask:0xf bank_mask:0xf bound_ctrl:0
    s_nop 1
    v_add_u32_dpp v39, v39, v39 row_shr:8 row_mask:0xf bank_mask:0xf bound_ctrl:0
    s_nop 1
    v_add_u32_dpp v39, v39, v39 row_bcast:15 row_mask:0xa bank_mask:0xf
    s_nop 1
    v_add_u32_dpp v39, v39, v39 row_bcast:31 row_mask:0xc bank_mask:0xf
    v_sub_u32 v39, v39, v38
    v_add_u32 v47, v39, v46
    v_add_u32 v46, v39, v45
    v_add_u32 v45, v39, v44
    v_mov_b32 v44, v39
    ds_write_b128 v40, v[44:47]
    v_lshlrev_b32 v41, 4, v0
    s_lshl_b32 s53, s49, 10
    s_add_u32 s53, s53, 20480000
    buffer_store_dwordx4 v[44:47], v41, s[24:27], s53 offen
    s_waitcnt lgkmcnt(0)
    v_lshlrev_b32 v42, 2, v10
    v_add_u32 v42, s52, v42
    ds_read_b32 v32, v42
    v_lshlrev_b32 v42, 2, v11
    v_add_u32 v42, s52, v42
    ds_read_b32 v33, v42
    v_lshlrev_b32 v42, 2, v12
    v_add_u32 v42, s52, v42
    ds_read_b32 v34, v42
    s_mul_i32 s53, s49, 5120
    s_add_u32 s53, s53, 15360000
    s_waitcnt lgkmcnt(0)
    v_add_u32 v32, v32, v16
    v_lshlrev_b32 v32, 5, v32
    buffer_store_dwordx4 v[48:51], v32, s[24:27], s53 offen
    buffer_store_dwordx4 v[52:55], v32, s[24:27], s53 offen offset:16
    v_add_u32 v33, v33, v17
    v_lshlrev_b32 v33, 5, v33
    buffer_store_dwordx4 v[56:59], v33, s[24:27], s53 offen
    buffer_store_dwordx4 v[60:63], v33, s[24:27], s53 offen offset:16
    v_add_u32 v34, v34, v18
    v_lshlrev_b32 v34, 5, v34
    v_cmp_gt_u32 vcc, 32, v0
    s_and_saveexec_b64 s[54:55], vcc
    buffer_store_dwordx4 v[64:67], v34, s[24:27], s53 offen
    buffer_store_dwordx4 v[68:71], v34, s[24:27], s53 offen offset:16
    s_mov_b64 exec, s[54:55]
    s_cmp_lg_u32 s3, 4
    s_cbranch_scc1 k1_nod2
k1_nod2:
    s_cmp_ge_u32 s2, 64
    s_cbranch_scc1 k1_end
    s_lshl_b32 s53, s2, 2
    s_add_u32 s53, s53, s48
    s_lshr_b32 s54, s53, 4
    s_and_b32 s55, s53, 15
    v_and_b32 v1, 15, v0
    s_lshl_b32 s56, s54, 4
    v_add_u32 v1, s56, v1
    v_lshlrev_b32 v1, 1, v1
    v_lshrrev_b32 v2, 4, v0
    v_lshlrev_b32 v2, 3, v2
    s_lshl_b32 s56, s55, 5
    v_add_u32 v2, s56, v2
    s_cmp_ge_u32 s55, 8
    s_cbranch_scc1 k1_whf_perm
    v_add_u32 v3, 0, v2
    v_lshlrev_b32 v3, 9, v3
    v_add_u32 v3, v3, v1
    buffer_load_ushort v8, v3, s[44:47], 0 offen
    v_add_u32 v3, 1, v2
    v_lshlrev_b32 v3, 9, v3
    v_add_u32 v3, v3, v1
    buffer_load_ushort v9, v3, s[44:47], 0 offen
    v_add_u32 v3, 2, v2
    v_lshlrev_b32 v3, 9, v3
    v_add_u32 v3, v3, v1
    buffer_load_ushort v10, v3, s[44:47], 0 offen
    v_add_u32 v3, 3, v2
    v_lshlrev_b32 v3, 9, v3
    v_add_u32 v3, v3, v1
    buffer_load_ushort v11, v3, s[44:47], 0 offen
    v_add_u32 v3, 4, v2
    v_lshlrev_b32 v3, 9, v3
    v_add_u32 v3, v3, v1
    buffer_load_ushort v12, v3, s[44:47], 0 offen
    v_add_u32 v3, 5, v2
    v_lshlrev_b32 v3, 9, v3
    v_add_u32 v3, v3, v1
    buffer_load_ushort v13, v3, s[44:47], 0 offen
    v_add_u32 v3, 6, v2
    v_lshlrev_b32 v3, 9, v3
    v_add_u32 v3, v3, v1
    buffer_load_ushort v14, v3, s[44:47], 0 offen
    v_add_u32 v3, 7, v2
    v_lshlrev_b32 v3, 9, v3
    v_add_u32 v3, v3, v1
    buffer_load_ushort v15, v3, s[44:47], 0 offen
    s_branch k1_whf_pack
k1_whf_perm:
    v_add_u32 v3, 4294967040, v2
    v_lshrrev_b32 v4, 6, v3
    v_lshlrev_b32 v4, 2, v4
    v_and_b32 v5, 3, v3
    v_add_u32 v4, v4, v5
    v_bfe_u32 v5, v3, 2, 4
    v_lshlrev_b32 v5, 3, v5
    v_and_b32 v6, 7, v4
    v_add_u32 v5, v5, v6
    v_lshrrev_b32 v6, 3, v4
    v_lshlrev_b32 v6, 7, v6
    v_add_u32 v5, v5, v6
    v_add_u32 v5, 256, v5
    v_lshlrev_b32 v5, 9, v5
    v_add_u32 v5, v5, v1
    buffer_load_ushort v8, v5, s[44:47], 0 offen
    v_add_u32 v3, 4294967041, v2
    v_lshrrev_b32 v4, 6, v3
    v_lshlrev_b32 v4, 2, v4
    v_and_b32 v5, 3, v3
    v_add_u32 v4, v4, v5
    v_bfe_u32 v5, v3, 2, 4
    v_lshlrev_b32 v5, 3, v5
    v_and_b32 v6, 7, v4
    v_add_u32 v5, v5, v6
    v_lshrrev_b32 v6, 3, v4
    v_lshlrev_b32 v6, 7, v6
    v_add_u32 v5, v5, v6
    v_add_u32 v5, 256, v5
    v_lshlrev_b32 v5, 9, v5
    v_add_u32 v5, v5, v1
    buffer_load_ushort v9, v5, s[44:47], 0 offen
    v_add_u32 v3, 4294967042, v2
    v_lshrrev_b32 v4, 6, v3
    v_lshlrev_b32 v4, 2, v4
    v_and_b32 v5, 3, v3
    v_add_u32 v4, v4, v5
    v_bfe_u32 v5, v3, 2, 4
    v_lshlrev_b32 v5, 3, v5
    v_and_b32 v6, 7, v4
    v_add_u32 v5, v5, v6
    v_lshrrev_b32 v6, 3, v4
    v_lshlrev_b32 v6, 7, v6
    v_add_u32 v5, v5, v6
    v_add_u32 v5, 256, v5
    v_lshlrev_b32 v5, 9, v5
    v_add_u32 v5, v5, v1
    buffer_load_ushort v10, v5, s[44:47], 0 offen
    v_add_u32 v3, 4294967043, v2
    v_lshrrev_b32 v4, 6, v3
    v_lshlrev_b32 v4, 2, v4
    v_and_b32 v5, 3, v3
    v_add_u32 v4, v4, v5
    v_bfe_u32 v5, v3, 2, 4
    v_lshlrev_b32 v5, 3, v5
    v_and_b32 v6, 7, v4
    v_add_u32 v5, v5, v6
    v_lshrrev_b32 v6, 3, v4
    v_lshlrev_b32 v6, 7, v6
    v_add_u32 v5, v5, v6
    v_add_u32 v5, 256, v5
    v_lshlrev_b32 v5, 9, v5
    v_add_u32 v5, v5, v1
    buffer_load_ushort v11, v5, s[44:47], 0 offen
    v_add_u32 v3, 4294967044, v2
    v_lshrrev_b32 v4, 6, v3
    v_lshlrev_b32 v4, 2, v4
    v_and_b32 v5, 3, v3
    v_add_u32 v4, v4, v5
    v_bfe_u32 v5, v3, 2, 4
    v_lshlrev_b32 v5, 3, v5
    v_and_b32 v6, 7, v4
    v_add_u32 v5, v5, v6
    v_lshrrev_b32 v6, 3, v4
    v_lshlrev_b32 v6, 7, v6
    v_add_u32 v5, v5, v6
    v_add_u32 v5, 256, v5
    v_lshlrev_b32 v5, 9, v5
    v_add_u32 v5, v5, v1
    buffer_load_ushort v12, v5, s[44:47], 0 offen
    v_add_u32 v3, 4294967045, v2
    v_lshrrev_b32 v4, 6, v3
    v_lshlrev_b32 v4, 2, v4
    v_and_b32 v5, 3, v3
    v_add_u32 v4, v4, v5
    v_bfe_u32 v5, v3, 2, 4
    v_lshlrev_b32 v5, 3, v5
    v_and_b32 v6, 7, v4
    v_add_u32 v5, v5, v6
    v_lshrrev_b32 v6, 3, v4
    v_lshlrev_b32 v6, 7, v6
    v_add_u32 v5, v5, v6
    v_add_u32 v5, 256, v5
    v_lshlrev_b32 v5, 9, v5
    v_add_u32 v5, v5, v1
    buffer_load_ushort v13, v5, s[44:47], 0 offen
    v_add_u32 v3, 4294967046, v2
    v_lshrrev_b32 v4, 6, v3
    v_lshlrev_b32 v4, 2, v4
    v_and_b32 v5, 3, v3
    v_add_u32 v4, v4, v5
    v_bfe_u32 v5, v3, 2, 4
    v_lshlrev_b32 v5, 3, v5
    v_and_b32 v6, 7, v4
    v_add_u32 v5, v5, v6
    v_lshrrev_b32 v6, 3, v4
    v_lshlrev_b32 v6, 7, v6
    v_add_u32 v5, v5, v6
    v_add_u32 v5, 256, v5
    v_lshlrev_b32 v5, 9, v5
    v_add_u32 v5, v5, v1
    buffer_load_ushort v14, v5, s[44:47], 0 offen
    v_add_u32 v3, 4294967047, v2
    v_lshrrev_b32 v4, 6, v3
    v_lshlrev_b32 v4, 2, v4
    v_and_b32 v5, 3, v3
    v_add_u32 v4, v4, v5
    v_bfe_u32 v5, v3, 2, 4
    v_lshlrev_b32 v5, 3, v5
    v_and_b32 v6, 7, v4
    v_add_u32 v5, v5, v6
    v_lshrrev_b32 v6, 3, v4
    v_lshlrev_b32 v6, 7, v6
    v_add_u32 v5, v5, v6
    v_add_u32 v5, 256, v5
    v_lshlrev_b32 v5, 9, v5
    v_add_u32 v5, v5, v1
    buffer_load_ushort v15, v5, s[44:47], 0 offen
k1_whf_pack:
    s_waitcnt vmcnt(0)
    v_lshl_or_b32 v20, v9, 16, v8
    v_lshl_or_b32 v21, v11, 16, v10
    v_lshl_or_b32 v22, v13, 16, v12
    v_lshl_or_b32 v23, v15, 16, v14
    v_lshlrev_b32 v3, 4, v0
    s_lshl_b32 s53, s53, 10
    s_add_u32 s53, s53, 21504000
    buffer_store_dwordx4 v[20:23], v3, s[24:27], s53 offen
k1_end:
    s_endpgm
.globl k2_kernel
.p2align 8
.type k2_kernel,@function
k2_kernel:
    s_cmp_ge_u32 s2, 250
    s_cbranch_scc1 k2_end
    s_load_dwordx4 s[4:7], s[0:1], 0
    s_load_dwordx2 s[14:15], s[0:1], 40
    s_load_dwordx2 s[16:17], s[0:1], 48
    s_load_dwordx2 s[22:23], s[0:1], 64
    s_load_dwordx2 s[20:21], s[0:1], 80
    v_and_b32 v1, 15, v0
    v_lshlrev_b32 v1, 4, v1
    v_lshrrev_b32 v9, 6, v0
    s_nop 0
    v_readfirstlane_b32 s3, v9
    s_waitcnt lgkmcnt(0)
    s_mov_b32 s24, s20
    s_mov_b32 s25, s21
    s_mov_b32 s26, 21766144
    s_mov_b32 s27, 0x00020000
    s_mov_b32 s28, s4
    s_mov_b32 s29, s5
    s_mov_b32 s30, 5120000
    s_mov_b32 s31, 0x00020000
    s_mov_b32 s32, s22
    s_mov_b32 s33, s23
    s_mov_b32 s34, 5180000
    s_mov_b32 s35, 0x00020000
    s_mov_b32 s36, s6
    s_mov_b32 s37, s7
    s_mov_b32 s38, 60000
    s_mov_b32 s39, 0x00020000
    s_mov_b32 s40, s14
    s_mov_b32 s41, s15
    s_mov_b32 s42, 263168
    s_mov_b32 s43, 0x00020000
    s_mov_b32 s44, s16
    s_mov_b32 s45, s17
    s_mov_b32 s46, 512
    s_mov_b32 s47, 0x00020000
    s_mul_i32 s48, s2, 40960
    v_mov_b32 v20, 0
    v_mov_b32 v21, 0
    v_mov_b32 v22, 0
    v_mov_b32 v23, 0
    v_lshlrev_b32 v9, 4, v0
    ds_write_b128 v9, v[20:23] offset:4096
    ds_write_b128 v9, v[20:23] offset:20480
    v_cmp_gt_u32 vcc, 512, v0
    s_and_saveexec_b64 s[50:51], vcc
    ds_write_b128 v9, v[20:23] offset:36864
    s_mov_b64 exec, s[50:51]
    v_lshlrev_b32 v10, 2, v0
    v_cmp_gt_u32 vcc, 640, v0
    s_and_saveexec_b64 s[50:51], vcc
    ds_write_b32 v10, v20 offset:0
    s_mov_b64 exec, s[50:51]
    v_mov_b32 v19, 0
k2_round0:
    v_mov_b32 v24, 0
    v_mov_b32 v25, 0
    v_lshlrev_b32 v10, 10, v0
    s_lshl_b32 s49, s2, 2
    s_add_u32 s49, s49, 20480000
    v_cmp_gt_u32 vcc, 1000, v0
    s_and_saveexec_b64 s[50:51], vcc
    buffer_load_dwordx2 v[24:25], v10, s[24:27], s49 offen
    s_mov_b64 exec, s[50:51]
    s_mov_b32 s49, 262144
    buffer_load_dwordx4 v[100:103], v1, s[40:43], s49 offen
    buffer_load_dwordx4 v[104:107], v1, s[40:43], s49 offen offset:256
    buffer_load_dwordx4 v[108:111], v1, s[40:43], s49 offen offset:512
    buffer_load_dwordx4 v[112:115], v1, s[40:43], s49 offen offset:768
    buffer_load_dwordx4 v[116:119], v1, s[44:47], 0 offen
    buffer_load_dwordx4 v[120:123], v1, s[44:47], 0 offen offset:256
    v_mul_u32_u24 v26, 5120, v0
k2_round:
    buffer_load_dwordx4 v[28:31], v9, s[24:27], s48 offen
    s_add_u32 s49, s48, 16384
    buffer_load_dwordx4 v[32:35], v9, s[24:27], s49 offen
    s_add_u32 s49, s48, 32768
    v_cmp_gt_u32 vcc, 512, v0
    s_and_saveexec_b64 s[50:51], vcc
    buffer_load_dwordx4 v[36:39], v9, s[24:27], s49 offen
    s_mov_b64 exec, s[50:51]
    s_waitcnt vmcnt(0)
    v_add_u32 v10, 45056, v9
    ds_write_b128 v10, v[28:31]
    ds_write_b128 v10, v[32:35] offset:16384
    v_cmp_gt_u32 vcc, 512, v0
    s_and_saveexec_b64 s[50:51], vcc
    ds_write_b128 v10, v[36:39] offset:32768
    s_mov_b64 exec, s[50:51]
    v_add_u32 v24, v24, v19
    v_sub_u32 v27, v25, v24
    v_min_u32 v28, 8, v27
    s_waitcnt lgkmcnt(0)
    s_barrier
    v_mov_b32 v29, 2432
    ds_add_rtn_u32 v30, v29, v28
    s_waitcnt lgkmcnt(0)
    v_add_u32 v31, v30, v28
    v_cmp_lt_u32 vcc, 2048, v31
    s_and_saveexec_b64 s[50:51], vcc
    s_cbranch_execz k2_nocap
    ds_sub_u32 v29, v28
    v_mov_b32 v28, 0
k2_nocap:
    s_mov_b64 exec, s[50:51]
    v_cmp_lt_u32 vcc, v28, v27
    s_and_saveexec_b64 s[50:51], vcc
    s_cbranch_execz k2_noflag
    v_mov_b32 v29, 2436
    v_mov_b32 v30, 1
    ds_write_b32 v29, v30
k2_noflag:
    s_mov_b64 exec, s[50:51]
    v_lshlrev_b32 v29, 5, v24
    v_add_u32 v29, v29, v26
    s_mov_b32 s49, 15360000
    v_cmp_lt_u32 vcc, 0, v28
    s_and_saveexec_b64 s[50:51], vcc
    buffer_load_dwordx4 v[32:35], v29, s[24:27], s49 offen offset:0
    buffer_load_dwordx4 v[36:39], v29, s[24:27], s49 offen offset:16
    s_mov_b64 exec, s[50:51]
    v_cmp_lt_u32 vcc, 1, v28
    s_and_saveexec_b64 s[50:51], vcc
    buffer_load_dwordx4 v[40:43], v29, s[24:27], s49 offen offset:32
    buffer_load_dwordx4 v[44:47], v29, s[24:27], s49 offen offset:48
    s_mov_b64 exec, s[50:51]
    v_cmp_lt_u32 vcc, 2, v28
    s_and_saveexec_b64 s[50:51], vcc
    buffer_load_dwordx4 v[48:51], v29, s[24:27], s49 offen offset:64
    buffer_load_dwordx4 v[52:55], v29, s[24:27], s49 offen offset:80
    s_mov_b64 exec, s[50:51]
    v_cmp_lt_u32 vcc, 3, v28
    s_and_saveexec_b64 s[50:51], vcc
    buffer_load_dwordx4 v[56:59], v29, s[24:27], s49 offen offset:96
    buffer_load_dwordx4 v[60:63], v29, s[24:27], s49 offen offset:112
    s_mov_b64 exec, s[50:51]
    v_cmp_lt_u32 vcc, 4, v28
    s_and_saveexec_b64 s[50:51], vcc
    buffer_load_dwordx4 v[64:67], v29, s[24:27], s49 offen offset:128
    buffer_load_dwordx4 v[68:71], v29, s[24:27], s49 offen offset:144
    s_mov_b64 exec, s[50:51]
    v_cmp_lt_u32 vcc, 5, v28
    s_and_saveexec_b64 s[50:51], vcc
    buffer_load_dwordx4 v[72:75], v29, s[24:27], s49 offen offset:160
    buffer_load_dwordx4 v[76:79], v29, s[24:27], s49 offen offset:176
    s_mov_b64 exec, s[50:51]
    v_cmp_lt_u32 vcc, 6, v28
    s_and_saveexec_b64 s[50:51], vcc
    buffer_load_dwordx4 v[80:83], v29, s[24:27], s49 offen offset:192
    buffer_load_dwordx4 v[84:87], v29, s[24:27], s49 offen offset:208
    s_mov_b64 exec, s[50:51]
    v_cmp_lt_u32 vcc, 7, v28
    s_and_saveexec_b64 s[50:51], vcc
    buffer_load_dwordx4 v[88:91], v29, s[24:27], s49 offen offset:224
    buffer_load_dwordx4 v[92:95], v29, s[24:27], s49 offen offset:240
    s_mov_b64 exec, s[50:51]
    v_add_u32 v19, v19, v28
    v_mov_b32 v30, 1
    s_waitcnt vmcnt(0)
    v_cmp_lt_u32 vcc, 0, v28
    s_and_saveexec_b64 s[50:51], vcc
    v_lshrrev_b32 v29, 8, v35
    ds_add_rtn_u32 v39, v29, v30 offset:0
    s_mov_b64 exec, s[50:51]
    v_cmp_lt_u32 vcc, 1, v28
    s_and_saveexec_b64 s[50:51], vcc
    v_lshrrev_b32 v29, 8, v43
    ds_add_rtn_u32 v47, v29, v30 offset:0
    s_mov_b64 exec, s[50:51]
    v_cmp_lt_u32 vcc, 2, v28
    s_and_saveexec_b64 s[50:51], vcc
    v_lshrrev_b32 v29, 8, v51
    ds_add_rtn_u32 v55, v29, v30 offset:0
    s_mov_b64 exec, s[50:51]
    v_cmp_lt_u32 vcc, 3, v28
    s_and_saveexec_b64 s[50:51], vcc
    v_lshrrev_b32 v29, 8, v59
    ds_add_rtn_u32 v63, v29, v30 offset:0
    s_mov_b64 exec, s[50:51]
    v_cmp_lt_u32 vcc, 4, v28
    s_and_saveexec_b64 s[50:51], vcc
    v_lshrrev_b32 v29, 8, v67
    ds_add_rtn_u32 v71, v29, v30 offset:0
    s_mov_b64 exec, s[50:51]
    v_cmp_lt_u32 vcc, 5, v28
    s_and_saveexec_b64 s[50:51], vcc
    v_lshrrev_b32 v29, 8, v75
    ds_add_rtn_u32 v79, v29, v30 offset:0
    s_mov_b64 exec, s[50:51]
    v_cmp_lt_u32 vcc, 6, v28
    s_and_saveexec_b64 s[50:51], vcc
    v_lshrrev_b32 v29, 8, v83
    ds_add_rtn_u32 v87, v29, v30 offset:0
    s_mov_b64 exec, s[50:51]
    v_cmp_lt_u32 vcc, 7, v28
    s_and_saveexec_b64 s[50:51], vcc
    v_lshrrev_b32 v29, 8, v91
    ds_add_rtn_u32 v95, v29, v30 offset:0
    s_mov_b64 exec, s[50:51]
    s_waitcnt lgkmcnt(0)
    s_barrier
    s_cmp_lg_u32 s3, 0
    s_cbranch_scc1 k2_scan_done
    v_lshlrev_b32 v29, 2, v0
    ds_read_b32 v30, v29 offset:0
    s_waitcnt lgkmcnt(0)
    v_mov_b32 v31, v30
    s_nop 1
    v_add_u32_dpp v31, v31, v31 row_shr:1 row_mask:0xf bank_mask:0xf bound_ctrl:0
    s_nop 1
    v_add_u32_dpp v31, v31, v31 row_shr:2 row_mask:0xf bank_mask:0xf bound_ctrl:0
    s_nop 1
    v_add_u32_dpp v31, v31, v31 row_shr:4 row_mask:0xf bank_mask:0xf bound_ctrl:0
    s_nop 1
    v_add_u32_dpp v31, v31, v31 row_shr:8 row_mask:0xf bank_mask:0xf bound_ctrl:0
    s_nop 1
    v_add_u32_dpp v31, v31, v31 row_bcast:15 row_mask:0xa bank_mask:0xf
    s_nop 1
    v_add_u32_dpp v31, v31, v31 row_bcast:31 row_mask:0xc bank_mask:0xf
    v_sub_u32 v31, v31, v30
    ds_write_b32 v29, v31 offset:256
    s_waitcnt lgkmcnt(0)
k2_scan_done:
    s_barrier
    v_mov_b32 v31, 86016
    v_cmp_lt_u32 vcc, 0, v28
    s_and_saveexec_b64 s[50:51], vcc
    v_lshrrev_b32 v29, 8, v35
    ds_read_b32 v30, v29 offset:256
    s_waitcnt lgkmcnt(0)
    v_add_u32 v30, v30, v39
    v_lshl_add_u32 v30, v30, 5, v31
    ds_write_b128 v30, v[32:35]
    ds_write_b128 v30, v[36:39] offset:16
    s_mov_b64 exec, s[50:51]
    v_cmp_lt_u32 vcc, 1, v28
    s_and_saveexec_b64 s[50:51], vcc
    v_lshrrev_b32 v29, 8, v43
    ds_read_b32 v30, v29 offset:256
    s_waitcnt lgkmcnt(0)
    v_add_u32 v30, v30, v47
    v_lshl_add_u32 v30, v30, 5, v31
    ds_write_b128 v30, v[40:43]
    ds_write_b128 v30, v[44:47] offset:16
    s_mov_b64 exec, s[50:51]
    v_cmp_lt_u32 vcc, 2, v28
    s_and_saveexec_b64 s[50:51], vcc
    v_lshrrev_b32 v29, 8, v51
    ds_read_b32 v30, v29 offset:256
    s_waitcnt lgkmcnt(0)
    v_add_u32 v30, v30, v55
    v_lshl_add_u32 v30, v30, 5, v31
    ds_write_b128 v30, v[48:51]
    ds_write_b128 v30, v[52:55] offset:16
    s_mov_b64 exec, s[50:51]
    v_cmp_lt_u32 vcc, 3, v28
    s_and_saveexec_b64 s[50:51], vcc
    v_lshrrev_b32 v29, 8, v59
    ds_read_b32 v30, v29 offset:256
    s_waitcnt lgkmcnt(0)
    v_add_u32 v30, v30, v63
    v_lshl_add_u32 v30, v30, 5, v31
    ds_write_b128 v30, v[56:59]
    ds_write_b128 v30, v[60:63] offset:16
    s_mov_b64 exec, s[50:51]
    v_cmp_lt_u32 vcc, 4, v28
    s_and_saveexec_b64 s[50:51], vcc
    v_lshrrev_b32 v29, 8, v67
    ds_read_b32 v30, v29 offset:256
    s_waitcnt lgkmcnt(0)
    v_add_u32 v30, v30, v71
    v_lshl_add_u32 v30, v30, 5, v31
    ds_write_b128 v30, v[64:67]
    ds_write_b128 v30, v[68:71] offset:16
    s_mov_b64 exec, s[50:51]
    v_cmp_lt_u32 vcc, 5, v28
    s_and_saveexec_b64 s[50:51], vcc
    v_lshrrev_b32 v29, 8, v75
    ds_read_b32 v30, v29 offset:256
    s_waitcnt lgkmcnt(0)
    v_add_u32 v30, v30, v79
    v_lshl_add_u32 v30, v30, 5, v31
    ds_write_b128 v30, v[72:75]
    ds_write_b128 v30, v[76:79] offset:16
    s_mov_b64 exec, s[50:51]
    v_cmp_lt_u32 vcc, 6, v28
    s_and_saveexec_b64 s[50:51], vcc
    v_lshrrev_b32 v29, 8, v83
    ds_read_b32 v30, v29 offset:256
    s_waitcnt lgkmcnt(0)
    v_add_u32 v30, v30, v87
    v_lshl_add_u32 v30, v30, 5, v31
    ds_write_b128 v30, v[80:83]
    ds_write_b128 v30, v[84:87] offset:16
    s_mov_b64 exec, s[50:51]
    v_cmp_lt_u32 vcc, 7, v28
    s_and_saveexec_b64 s[50:51], vcc
    v_lshrrev_b32 v29, 8, v91
    ds_read_b32 v30, v29 offset:256
    s_waitcnt lgkmcnt(0)
    v_add_u32 v30, v30, v95
    v_lshl_add_u32 v30, v30, 5, v31
    ds_write_b128 v30, v[88:91]
    ds_write_b128 v30, v[92:95] offset:16
    s_mov_b64 exec, s[50:51]
    v_mov_b32 v29, 416
    ds_read_b32 v30, v29
    s_waitcnt lgkmcnt(0)
    v_readfirstlane_b32 s52, v30
    s_barrier
    v_lshlrev_b32 v36, 16, v100
    v_and_b32 v37, 0xffff0000, v100
    v_lshlrev_b32 v52, 16, v108
    v_and_b32 v53, 0xffff0000, v108
    v_lshlrev_b32 v38, 16, v101
    v_and_b32 v39, 0xffff0000, v101
    v_lshlrev_b32 v54, 16, v109
    v_and_b32 v55, 0xffff0000, v109
    v_lshlrev_b32 v40, 16, v102
    v_and_b32 v41, 0xffff0000, v102
    v_lshlrev_b32 v56, 16, v110
    v_and_b32 v57, 0xffff0000, v110
    v_lshlrev_b32 v42, 16, v103
    v_and_b32 v43, 0xffff0000, v103
    v_lshlrev_b32 v58, 16, v111
    v_and_b32 v59, 0xffff0000, v111
    v_lshlrev_b32 v44, 16, v104
    v_and_b32 v45, 0xffff0000, v104
    v_lshlrev_b32 v60, 16, v112
    v_and_b32 v61, 0xffff0000, v112
    v_lshlrev_b32 v46, 16, v105
    v_and_b32 v47, 0xffff0000, v105
    v_lshlrev_b32 v62, 16, v113
    v_and_b32 v63, 0xffff0000, v113
    v_lshlrev_b32 v48, 16, v106
    v_and_b32 v49, 0xffff0000, v106
    v_lshlrev_b32 v64, 16, v114
    v_and_b32 v65, 0xffff0000, v114
    v_lshlrev_b32 v50, 16, v107
    v_and_b32 v51, 0xffff0000, v107
    v_lshlrev_b32 v66, 16, v115
    v_and_b32 v67, 0xffff0000, v115
    v_lshlrev_b32 v68, 16, v116
    v_and_b32 v69, 0xffff0000, v116
    v_lshlrev_b32 v70, 16, v117
    v_and_b32 v71, 0xffff0000, v117
    v_lshlrev_b32 v72, 16, v118
    v_and_b32 v73, 0xffff0000, v118
    v_lshlrev_b32 v74, 16, v119
    v_and_b32 v75, 0xffff0000, v119
    v_lshlrev_b32 v76, 16, v120
    v_and_b32 v77, 0xffff0000, v120
    v_lshlrev_b32 v78, 16, v121
    v_and_b32 v79, 0xffff0000, v121
    v_lshlrev_b32 v80, 16, v122
    v_and_b32 v81, 0xffff0000, v122
    v_lshlrev_b32 v82, 16, v123
    v_and_b32 v83, 0xffff0000, v123
    v_mul_f32 v36, 0xbfb8aa3b, v36
    v_mul_f32 v52, 0xbfb8aa3b, v52
    v_mul_f32 v37, 0xbfb8aa3b, v37
    v_mul_f32 v53, 0xbfb8aa3b, v53
    v_mul_f32 v38, 0xbfb8aa3b, v38
    v_mul_f32 v54, 0xbfb8aa3b, v54
    v_mul_f32 v39, 0xbfb8aa3b, v39
    v_mul_f32 v55, 0xbfb8aa3b, v55
    v_mul_f32 v40, 0xbfb8aa3b, v40
    v_mul_f32 v56, 0xbfb8aa3b, v56
    v_mul_f32 v41, 0xbfb8aa3b, v41
    v_mul_f32 v57, 0xbfb8aa3b, v57
    v_mul_f32 v42, 0xbfb8aa3b, v42
    v_mul_f32 v58, 0xbfb8aa3b, v58
    v_mul_f32 v43, 0xbfb8aa3b, v43
    v_mul_f32 v59, 0xbfb8aa3b, v59
    v_mul_f32 v44, 0xbfb8aa3b, v44
    v_mul_f32 v60, 0xbfb8aa3b, v60
    v_mul_f32 v45, 0xbfb8aa3b, v45
    v_mul_f32 v61, 0xbfb8aa3b, v61
    v_mul_f32 v46, 0xbfb8aa3b, v46
    v_mul_f32 v62, 0xbfb8aa3b, v62
    v_mul_f32 v47, 0xbfb8aa3b, v47
    v_mul_f32 v63, 0xbfb8aa3b, v63
    v_mul_f32 v48, 0xbfb8aa3b, v48
    v_mul_f32 v64, 0xbfb8aa3b, v64
    v_mul_f32 v49, 0xbfb8aa3b, v49
    v_mul_f32 v65, 0xbfb8aa3b, v65
    v_mul_f32 v50, 0xbfb8aa3b, v50
    v_mul_f32 v66, 0xbfb8aa3b, v66
    v_mul_f32 v51, 0xbfb8aa3b, v51
    v_mul_f32 v67, 0xbfb8aa3b, v67
    s_add_u32 s53, s52, 63
    s_lshr_b32 s53, s53, 6
    v_lshrrev_b32 v9, 4, v0
    v_mul_u32_u24 v2, s53, v9
    v_min_u32 v2, s52, v2
    v_add_u32 v3, s53, v2
    v_min_u32 v3, s52, v3
    v_lshlrev_b32 v6, 5, v2
    v_add_u32 v6, 86016, v6
    v_lshrrev_b32 v7, 4, v1
    v_min_u32 v7, 3, v7
    v_lshlrev_b32 v7, 2, v7
    v_add_u32 v7, 16, v7
    v_mov_b32 v20, 0
    v_mov_b32 v21, 0
    v_mov_b32 v22, 0
    v_mov_b32 v23, 0
    v_mov_b32 v24, 0
    v_mov_b32 v25, 0
    v_mov_b32 v26, 0
    v_mov_b32 v27, 0
    v_mov_b32 v28, 0
    v_mov_b32 v29, 0
    v_mov_b32 v30, 0
    v_mov_b32 v31, 0
    v_mov_b32 v32, 0
    v_mov_b32 v33, 0
    v_mov_b32 v34, 0
    v_mov_b32 v35, 0
    v_mov_b32 v5, 0
    ds_read_b128 v[12:15], v6
    v_add_u32 v9, v6, v7
    ds_read_b32 v16, v9
    ds_read_b32 v8, v6 offset:32
    s_waitcnt lgkmcnt(0)
    v_mov_b32 v4, v15
    v_add_u32 v9, v12, v1
    s_mov_b32 s54, 10240000
    buffer_load_dwordx4 v[100:103], v9, s[24:27], s54 offen
    buffer_load_dwordx4 v[104:107], v9, s[24:27], s54 offen offset:256
    s_mov_b32 s55, 0
k2_step0:
    v_cmp_lt_u32 vcc, v2, v3
    s_mov_b64 exec, vcc
    s_cbranch_execz k2_loop_done
    v_cmp_ne_u32 vcc, v15, v4
    s_cbranch_vccnz k2_flush0
k2_back0:
    v_add_u32 v9, v15, v1
    ds_read_b128 v[84:87], v9 offset:45056
    ds_read_b128 v[88:91], v9 offset:45312
    ds_read_b128 v[92:95], v9 offset:45568
    ds_read_b128 v[96:99], v9 offset:45824
    v_add_u32 v10, v8, v1
    buffer_load_dwordx4 v[108:111], v10, s[24:27], s54 offen
    buffer_load_dwordx4 v[112:115], v10, s[24:27], s54 offen offset:256
    v_add_u32 v2, 1, v2
    v_add_u32 v6, 32, v6
    v_mov_b32 v17, 0
    s_waitcnt vmcnt(2) lgkmcnt(0)
    v_lshlrev_b32 v116, 16, v100
    v_and_b32 v117, 0xffff0000, v100
    v_fma_f32 v84, v13, v36, v84
    v_fma_f32 v85, v13, v37, v85
    v_fma_f32 v84, v14, v52, v84
    v_fma_f32 v85, v14, v53, v85
    v_add_f32 v84, v84, v116
    v_add_f32 v85, v85, v117
    v_exp_f32 v118, v84
    v_exp_f32 v119, v85
    v_add_f32 v118, 1.0, v118
    v_add_f32 v119, 1.0, v119
    v_rcp_f32 v118, v118
    v_rcp_f32 v119, v119
    v_mul_f32 v84, v84, v118
    v_mul_f32 v85, v85, v119
    v_add_f32 v20, v20, v84
    v_add_f32 v21, v21, v85
    v_fma_f32 v17, v84, v68, v17
    v_fma_f32 v17, v85, v69, v17
    v_lshlrev_b32 v122, 16, v101
    v_and_b32 v123, 0xffff0000, v101
    v_fma_f32 v86, v13, v38, v86
    v_fma_f32 v87, v13, v39, v87
    v_fma_f32 v86, v14, v54, v86
    v_fma_f32 v87, v14, v55, v87
    v_add_f32 v86, v86, v122
    v_add_f32 v87, v87, v123
    v_exp_f32 v124, v86
    v_exp_f32 v125, v87
    v_add_f32 v124, 1.0, v124
    v_add_f32 v125, 1.0, v125
    v_rcp_f32 v124, v124
    v_rcp_f32 v125, v125
    v_mul_f32 v86, v86, v124
    v_mul_f32 v87, v87, v125
    v_add_f32 v22, v22, v86
    v_add_f32 v23, v23, v87
    v_fma_f32 v17, v86, v70, v17
    v_fma_f32 v17, v87, v71, v17
    v_lshlrev_b32 v116, 16, v102
    v_and_b32 v117, 0xffff0000, v102
    v_fma_f32 v88, v13, v40, v88
    v_fma_f32 v89, v13, v41, v89
    v_fma_f32 v88, v14, v56, v88
    v_fma_f32 v89, v14, v57, v89
    v_add_f32 v88, v88, v116
    v_add_f32 v89, v89, v117
    v_exp_f32 v118, v88
    v_exp_f32 v119, v89
    v_add_f32 v118, 1.0, v118
    v_add_f32 v119, 1.0, v119
    v_rcp_f32 v118, v118
    v_rcp_f32 v119, v119
    v_mul_f32 v88, v88, v118
    v_mul_f32 v89, v89, v119
    v_add_f32 v24, v24, v88
    v_add_f32 v25, v25, v89
    v_fma_f32 v17, v88, v72, v17
    v_fma_f32 v17, v89, v73, v17
    v_lshlrev_b32 v122, 16, v103
    v_and_b32 v123, 0xffff0000, v103
    v_fma_f32 v90, v13, v42, v90
    v_fma_f32 v91, v13, v43, v91
    v_fma_f32 v90, v14, v58, v90
    v_fma_f32 v91, v14, v59, v91
    v_add_f32 v90, v90, v122
    v_add_f32 v91, v91, v123
    v_exp_f32 v124, v90
    v_exp_f32 v125, v91
    v_add_f32 v124, 1.0, v124
    v_add_f32 v125, 1.0, v125
    v_rcp_f32 v124, v124
    v_rcp_f32 v125, v125
    v_mul_f32 v90, v90, v124
    v_mul_f32 v91, v91, v125
    v_add_f32 v26, v26, v90
    v_add_f32 v27, v27, v91
    v_fma_f32 v17, v90, v74, v17
    v_fma_f32 v17, v91, v75, v17
    v_lshlrev_b32 v116, 16, v104
    v_and_b32 v117, 0xffff0000, v104
    v_fma_f32 v92, v13, v44, v92
    v_fma_f32 v93, v13, v45, v93
    v_fma_f32 v92, v14, v60, v92
    v_fma_f32 v93, v14, v61, v93
    v_add_f32 v92, v92, v116
    v_add_f32 v93, v93, v117
    v_exp_f32 v118, v92
    v_exp_f32 v119, v93
    v_add_f32 v118, 1.0, v118
    v_add_f32 v119, 1.0, v119
    v_rcp_f32 v118, v118
    v_rcp_f32 v119, v119
    v_mul_f32 v92, v92, v118
    v_mul_f32 v93, v93, v119
    v_add_f32 v28, v28, v92
    v_add_f32 v29, v29, v93
    v_fma_f32 v17, v92, v76, v17
    v_fma_f32 v17, v93, v77, v17
    v_lshlrev_b32 v122, 16, v105
    v_and_b32 v123, 0xffff0000, v105
    v_fma_f32 v94, v13, v46, v94
    v_fma_f32 v95, v13, v47, v95
    v_fma_f32 v94, v14, v62, v94
    v_fma_f32 v95, v14, v63, v95
    v_add_f32 v94, v94, v122
    v_add_f32 v95, v95, v123
    v_exp_f32 v124, v94
    v_exp_f32 v125, v95
    v_add_f32 v124, 1.0, v124
    v_add_f32 v125, 1.0, v125
    v_rcp_f32 v124, v124
    v_rcp_f32 v125, v125
    v_mul_f32 v94, v94, v124
    v_mul_f32 v95, v95, v125
    v_add_f32 v30, v30, v94
    v_add_f32 v31, v31, v95
    v_fma_f32 v17, v94, v78, v17
    v_fma_f32 v17, v95, v79, v17
    v_lshlrev_b32 v116, 16, v106
    v_and_b32 v117, 0xffff0000, v106
    v_fma_f32 v96, v13, v48, v96
    v_fma_f32 v97, v13, v49, v97
    v_fma_f32 v96, v14, v64, v96
    v_fma_f32 v97, v14, v65, v97
    v_add_f32 v96, v96, v116
    v_add_f32 v97, v97, v117
    v_exp_f32 v118, v96
    v_exp_f32 v119, v97
    v_add_f32 v118, 1.0, v118
    v_add_f32 v119, 1.0, v119
    v_rcp_f32 v118, v118
    v_rcp_f32 v119, v119
    v_mul_f32 v96, v96, v118
    v_mul_f32 v97, v97, v119
    v_add_f32 v32, v32, v96
    v_add_f32 v33, v33, v97
    v_fma_f32 v17, v96, v80, v17
    v_fma_f32 v17, v97, v81, v17
    v_lshlrev_b32 v122, 16, v107
    v_and_b32 v123, 0xffff0000, v107
    v_fma_f32 v98, v13, v50, v98
    v_fma_f32 v99, v13, v51, v99
    v_fma_f32 v98, v14, v66, v98
    v_fma_f32 v99, v14, v67, v99
    v_add_f32 v98, v98, v122
    v_add_f32 v99, v99, v123
    v_exp_f32 v124, v98
    v_exp_f32 v125, v99
    v_add_f32 v124, 1.0, v124
    v_add_f32 v125, 1.0, v125
    v_rcp_f32 v124, v124
    v_rcp_f32 v125, v125
    v_mul_f32 v98, v98, v124
    v_mul_f32 v99, v99, v125
    v_add_f32 v34, v34, v98
    v_add_f32 v35, v35, v99
    v_fma_f32 v17, v98, v82, v17
    v_fma_f32 v17, v99, v83, v17
    v_mov_b32 v11, v16
    ds_read_b128 v[12:15], v6
    v_add_u32 v9, v6, v7
    ds_read_b32 v16, v9
    ds_read_b32 v8, v6 offset:32
    s_nop 1
    v_add_f32_dpp v17, v17, v17 row_ror:8 row_mask:0xf bank_mask:0xf
    s_nop 1
    v_add_f32_dpp v17, v17, v17 row_ror:4 row_mask:0xf bank_mask:0xf
    s_nop 1
    v_add_f32_dpp v17, v17, v17 row_ror:2 row_mask:0xf bank_mask:0xf
    s_nop 1
    v_add_f32_dpp v17, v17, v17 row_ror:1 row_mask:0xf bank_mask:0xf
    v_fma_f32 v5, v11, v17, v5
    s_add_u32 s55, s55, 1
    s_cmp_ge_u32 s55, s53
    s_cbranch_scc1 k2_loop_done
    s_waitcnt lgkmcnt(0)
k2_step1:
    v_cmp_lt_u32 vcc, v2, v3
    s_mov_b64 exec, vcc
    s_cbranch_execz k2_loop_done
    v_cmp_ne_u32 vcc, v15, v4
    s_cbranch_vccnz k2_flush1
k2_back1:
    v_add_u32 v9, v15, v1
    ds_read_b128 v[84:87], v9 offset:45056
    ds_read_b128 v[88:91], v9 offset:45312
    ds_read_b128 v[92:95], v9 offset:45568
    ds_read_b128 v[96:99], v9 offset:45824
    v_add_u32 v10, v8, v1
    buffer_load_dwordx4 v[100:103], v10, s[24:27], s54 offen
    buffer_load_dwordx4 v[104:107], v10, s[24:27], s54 offen offset:256
    v_add_u32 v2, 1, v2
    v_add_u32 v6, 32, v6
    v_mov_b32 v17, 0
    s_waitcnt vmcnt(2) lgkmcnt(0)
    v_lshlrev_b32 v116, 16, v108
    v_and_b32 v117, 0xffff0000, v108
    v_fma_f32 v84, v13, v36, v84
    v_fma_f32 v85, v13, v37, v85
    v_fma_f32 v84, v14, v52, v84
    v_fma_f32 v85, v14, v53, v85
    v_add_f32 v84, v84, v116
    v_add_f32 v85, v85, v117
    v_exp_f32 v118, v84
    v_exp_f32 v119, v85
    v_add_f32 v118, 1.0, v118
    v_add_f32 v119, 1.0, v119
    v_rcp_f32 v118, v118
    v_rcp_f32 v119, v119
    v_mul_f32 v84, v84, v118
    v_mul_f32 v85, v85, v119
    v_add_f32 v20, v20, v84
    v_add_f32 v21, v21, v85
    v_fma_f32 v17, v84, v68, v17
    v_fma_f32 v17, v85, v69, v17
    v_lshlrev_b32 v122, 16, v109
    v_and_b32 v123, 0xffff0000, v109
    v_fma_f32 v86, v13, v38, v86
    v_fma_f32 v87, v13, v39, v87
    v_fma_f32 v86, v14, v54, v86
    v_fma_f32 v87, v14, v55, v87
    v_add_f32 v86, v86, v122
    v_add_f32 v87, v87, v123
    v_exp_f32 v124, v86
    v_exp_f32 v125, v87
    v_add_f32 v124, 1.0, v124
    v_add_f32 v125, 1.0, v125
    v_rcp_f32 v124, v124
    v_rcp_f32 v125, v125
    v_mul_f32 v86, v86, v124
    v_mul_f32 v87, v87, v125
    v_add_f32 v22, v22, v86
    v_add_f32 v23, v23, v87
    v_fma_f32 v17, v86, v70, v17
    v_fma_f32 v17, v87, v71, v17
    v_lshlrev_b32 v116, 16, v110
    v_and_b32 v117, 0xffff0000, v110
    v_fma_f32 v88, v13, v40, v88
    v_fma_f32 v89, v13, v41, v89
    v_fma_f32 v88, v14, v56, v88
    v_fma_f32 v89, v14, v57, v89
    v_add_f32 v88, v88, v116
    v_add_f32 v89, v89, v117
    v_exp_f32 v118, v88
    v_exp_f32 v119, v89
    v_add_f32 v118, 1.0, v118
    v_add_f32 v119, 1.0, v119
    v_rcp_f32 v118, v118
    v_rcp_f32 v119, v119
    v_mul_f32 v88, v88, v118
    v_mul_f32 v89, v89, v119
    v_add_f32 v24, v24, v88
    v_add_f32 v25, v25, v89
    v_fma_f32 v17, v88, v72, v17
    v_fma_f32 v17, v89, v73, v17
    v_lshlrev_b32 v122, 16, v111
    v_and_b32 v123, 0xffff0000, v111
    v_fma_f32 v90, v13, v42, v90
    v_fma_f32 v91, v13, v43, v91
    v_fma_f32 v90, v14, v58, v90
    v_fma_f32 v91, v14, v59, v91
    v_add_f32 v90, v90, v122
    v_add_f32 v91, v91, v123
    v_exp_f32 v124, v90
    v_exp_f32 v125, v91
    v_add_f32 v124, 1.0, v124
    v_add_f32 v125, 1.0, v125
    v_rcp_f32 v124, v124
    v_rcp_f32 v125, v125
    v_mul_f32 v90, v90, v124
    v_mul_f32 v91, v91, v125
    v_add_f32 v26, v26, v90
    v_add_f32 v27, v27, v91
    v_fma_f32 v17, v90, v74, v17
    v_fma_f32 v17, v91, v75, v17
    v_lshlrev_b32 v116, 16, v112
    v_and_b32 v117, 0xffff0000, v112
    v_fma_f32 v92, v13, v44, v92
    v_fma_f32 v93, v13, v45, v93
    v_fma_f32 v92, v14, v60, v92
    v_fma_f32 v93, v14, v61, v93
    v_add_f32 v92, v92, v116
    v_add_f32 v93, v93, v117
    v_exp_f32 v118, v92
    v_exp_f32 v119, v93
    v_add_f32 v118, 1.0, v118
    v_add_f32 v119, 1.0, v119
    v_rcp_f32 v118, v118
    v_rcp_f32 v119, v119
    v_mul_f32 v92, v92, v118
    v_mul_f32 v93, v93, v119
    v_add_f32 v28, v28, v92
    v_add_f32 v29, v29, v93
    v_fma_f32 v17, v92, v76, v17
    v_fma_f32 v17, v93, v77, v17
    v_lshlrev_b32 v122, 16, v113
    v_and_b32 v123, 0xffff0000, v113
    v_fma_f32 v94, v13, v46, v94
    v_fma_f32 v95, v13, v47, v95
    v_fma_f32 v94, v14, v62, v94
    v_fma_f32 v95, v14, v63, v95
    v_add_f32 v94, v94, v122
    v_add_f32 v95, v95, v123
    v_exp_f32 v124, v94
    v_exp_f32 v125, v95
    v_add_f32 v124, 1.0, v124
    v_add_f32 v125, 1.0, v125
    v_rcp_f32 v124, v124
    v_rcp_f32 v125, v125
    v_mul_f32 v94, v94, v124
    v_mul_f32 v95, v95, v125
    v_add_f32 v30, v30, v94
    v_add_f32 v31, v31, v95
    v_fma_f32 v17, v94, v78, v17
    v_fma_f32 v17, v95, v79, v17
    v_lshlrev_b32 v116, 16, v114
    v_and_b32 v117, 0xffff0000, v114
    v_fma_f32 v96, v13, v48, v96
    v_fma_f32 v97, v13, v49, v97
    v_fma_f32 v96, v14, v64, v96
    v_fma_f32 v97, v14, v65, v97
    v_add_f32 v96, v96, v116
    v_add_f32 v97, v97, v117
    v_exp_f32 v118, v96
    v_exp_f32 v119, v97
    v_add_f32 v118, 1.0, v118
    v_add_f32 v119, 1.0, v119
    v_rcp_f32 v118, v118
    v_rcp_f32 v119, v119
    v_mul_f32 v96, v96, v118
    v_mul_f32 v97, v97, v119
    v_add_f32 v32, v32, v96
    v_add_f32 v33, v33, v97
    v_fma_f32 v17, v96, v80, v17
    v_fma_f32 v17, v97, v81, v17
    v_lshlrev_b32 v122, 16, v115
    v_and_b32 v123, 0xffff0000, v115
    v_fma_f32 v98, v13, v50, v98
    v_fma_f32 v99, v13, v51, v99
    v_fma_f32 v98, v14, v66, v98
    v_fma_f32 v99, v14, v67, v99
    v_add_f32 v98, v98, v122
    v_add_f32 v99, v99, v123
    v_exp_f32 v124, v98
    v_exp_f32 v125, v99
    v_add_f32 v124, 1.0, v124
    v_add_f32 v125, 1.0, v125
    v_rcp_f32 v124, v124
    v_rcp_f32 v125, v125
    v_mul_f32 v98, v98, v124
    v_mul_f32 v99, v99, v125
    v_add_f32 v34, v34, v98
    v_add_f32 v35, v35, v99
    v_fma_f32 v17, v98, v82, v17
    v_fma_f32 v17, v99, v83, v17
    v_mov_b32 v11, v16
    ds_read_b128 v[12:15], v6
    v_add_u32 v9, v6, v7
    ds_read_b32 v16, v9
    ds_read_b32 v8, v6 offset:32
    s_nop 1
    v_add_f32_dpp v17, v17, v17 row_ror:8 row_mask:0xf bank_mask:0xf
    s_nop 1
    v_add_f32_dpp v17, v17, v17 row_ror:4 row_mask:0xf bank_mask:0xf
    s_nop 1
    v_add_f32_dpp v17, v17, v17 row_ror:2 row_mask:0xf bank_mask:0xf
    s_nop 1
    v_add_f32_dpp v17, v17, v17 row_ror:1 row_mask:0xf bank_mask:0xf
    v_fma_f32 v5, v11, v17, v5
    s_add_u32 s55, s55, 1
    s_cmp_ge_u32 s55, s53
    s_cbranch_scc1 k2_loop_done
    s_waitcnt lgkmcnt(0)
    s_branch k2_step0
k2_flush0:
    s_and_saveexec_b64 s[56:57], vcc
    v_add_u32 v9, v4, v1
    ds_read_b128 v[84:87], v9 offset:4096
    ds_read_b128 v[88:91], v9 offset:4352
    ds_read_b128 v[92:95], v9 offset:4608
    ds_read_b128 v[96:99], v9 offset:4864
    v_lshrrev_b32 v10, 6, v4
    v_lshrrev_b32 v11, 2, v1
    v_add_u32 v10, v10, v11
    ds_read_b32 v18, v10 offset:768
    s_waitcnt lgkmcnt(0)
    v_add_f32 v84, v84, v20
    v_mov_b32 v20, 0
    v_add_f32 v85, v85, v21
    v_mov_b32 v21, 0
    v_add_f32 v86, v86, v22
    v_mov_b32 v22, 0
    v_add_f32 v87, v87, v23
    v_mov_b32 v23, 0
    v_add_f32 v88, v88, v24
    v_mov_b32 v24, 0
    v_add_f32 v89, v89, v25
    v_mov_b32 v25, 0
    v_add_f32 v90, v90, v26
    v_mov_b32 v26, 0
    v_add_f32 v91, v91, v27
    v_mov_b32 v27, 0
    v_add_f32 v92, v92, v28
    v_mov_b32 v28, 0
    v_add_f32 v93, v93, v29
    v_mov_b32 v29, 0
    v_add_f32 v94, v94, v30
    v_mov_b32 v30, 0
    v_add_f32 v95, v95, v31
    v_mov_b32 v31, 0
    v_add_f32 v96, v96, v32
    v_mov_b32 v32, 0
    v_add_f32 v97, v97, v33
    v_mov_b32 v33, 0
    v_add_f32 v98, v98, v34
    v_mov_b32 v34, 0
    v_add_f32 v99, v99, v35
    v_mov_b32 v35, 0
    ds_write_b128 v9, v[84:87] offset:4096
    ds_write_b128 v9, v[88:91] offset:4352
    ds_write_b128 v9, v[92:95] offset:4608
    ds_write_b128 v9, v[96:99] offset:4864
    v_add_f32 v18, v18, v5
    v_mov_b32 v5, 0
    v_cmp_gt_u32 vcc, 48, v1
    s_and_saveexec_b64 s[58:59], vcc
    ds_write_b32 v10, v18 offset:768
    s_mov_b64 exec, s[58:59]
    v_mov_b32 v4, v15
    s_waitcnt lgkmcnt(0)
    s_mov_b64 exec, s[56:57]
    s_branch k2_back0
k2_flush1:
    s_and_saveexec_b64 s[56:57], vcc
    v_add_u32 v9, v4, v1
    ds_read_b128 v[84:87], v9 offset:4096
    ds_read_b128 v[88:91], v9 offset:4352
    ds_read_b128 v[92:95], v9 offset:4608
    ds_read_b128 v[96:99], v9 offset:4864
    v_lshrrev_b32 v10, 6, v4
    v_lshrrev_b32 v11, 2, v1
    v_add_u32 v10, v10, v11
    ds_read_b32 v18, v10 offset:768
    s_waitcnt lgkmcnt(0)
    v_add_f32 v84, v84, v20
    v_mov_b32 v20, 0
    v_add_f32 v85, v85, v21
    v_mov_b32 v21, 0
    v_add_f32 v86, v86, v22
    v_mov_b32 v22, 0
    v_add_f32 v87, v87, v23
    v_mov_b32 v23, 0
    v_add_f32 v88, v88, v24
    v_mov_b32 v24, 0
    v_add_f32 v89, v89, v25
    v_mov_b32 v25, 0
    v_add_f32 v90, v90, v26
    v_mov_b32 v26, 0
    v_add_f32 v91, v91, v27
    v_mov_b32 v27, 0
    v_add_f32 v92, v92, v28
    v_mov_b32 v28, 0
    v_add_f32 v93, v93, v29
    v_mov_b32 v29, 0
    v_add_f32 v94, v94, v30
    v_mov_b32 v30, 0
    v_add_f32 v95, v95, v31
    v_mov_b32 v31, 0
    v_add_f32 v96, v96, v32
    v_mov_b32 v32, 0
    v_add_f32 v97, v97, v33
    v_mov_b32 v33, 0
    v_add_f32 v98, v98, v34
    v_mov_b32 v34, 0
    v_add_f32 v99, v99, v35
    v_mov_b32 v35, 0
    ds_write_b128 v9, v[84:87] offset:4096
    ds_write_b128 v9, v[88:91] offset:4352
    ds_write_b128 v9, v[92:95] offset:4608
    ds_write_b128 v9, v[96:99] offset:4864
    v_add_f32 v18, v18, v5
    v_mov_b32 v5, 0
    v_cmp_gt_u32 vcc, 48, v1
    s_and_saveexec_b64 s[58:59], vcc
    ds_write_b32 v10, v18 offset:768
    s_mov_b64 exec, s[58:59]
    v_mov_b32 v4, v15
    s_waitcnt lgkmcnt(0)
    s_mov_b64 exec, s[56:57]
    s_branch k2_back1
k2_loop_done:
    s_mov_b64 exec, -1
    s_waitcnt vmcnt(0) lgkmcnt(0)
    s_barrier
    v_and_b32 v116, 63, v0
    v_lshlrev_b32 v116, 4, v116
    s_lshl_b32 s49, s3, 14
    s_add_u32 s49, s49, 21504000
    s_add_u32 s51, s49, 0
    buffer_load_dwordx4 v[36:39], v116, s[24:27], s51 offen
    s_add_u32 s51, s49, 1024
    buffer_load_dwordx4 v[40:43], v116, s[24:27], s51 offen
    s_add_u32 s51, s49, 2048
    buffer_load_dwordx4 v[44:47], v116, s[24:27], s51 offen
    s_add_u32 s51, s49, 3072
    buffer_load_dwordx4 v[48:51], v116, s[24:27], s51 offen
    s_add_u32 s51, s49, 4096
    buffer_load_dwordx4 v[52:55], v116, s[24:27], s51 offen
    s_add_u32 s51, s49, 5120
    buffer_load_dwordx4 v[56:59], v116, s[24:27], s51 offen
    s_add_u32 s51, s49, 6144
    buffer_load_dwordx4 v[60:63], v116, s[24:27], s51 offen
    s_add_u32 s51, s49, 7168
    buffer_load_dwordx4 v[64:67], v116, s[24:27], s51 offen
    s_add_u32 s51, s49, 8192
    buffer_load_dwordx4 v[68:71], v116, s[24:27], s51 offen
    s_add_u32 s51, s49, 9216
    buffer_load_dwordx4 v[72:75], v116, s[24:27], s51 offen
    s_add_u32 s51, s49, 10240
    buffer_load_dwordx4 v[76:79], v116, s[24:27], s51 offen
    s_add_u32 s51, s49, 11264
    buffer_load_dwordx4 v[80:83], v116, s[24:27], s51 offen
    s_add_u32 s51, s49, 12288
    buffer_load_dwordx4 v[100:103], v116, s[24:27], s51 offen
    s_add_u32 s51, s49, 13312
    buffer_load_dwordx4 v[104:107], v116, s[24:27], s51 offen
    s_add_u32 s51, s49, 14336
    buffer_load_dwordx4 v[108:111], v116, s[24:27], s51 offen
    s_add_u32 s51, s49, 15360
    buffer_load_dwordx4 v[112:115], v116, s[24:27], s51 offen
    s_mul_i32 s50, s2, 40
    v_add_u32 v117, 0, v0
    v_lshrrev_b32 v118, 5, v117
    v_add_u32 v118, s50, v118
    v_min_u32 v118, 9999, v118
    v_lshlrev_b32 v118, 9, v118
    v_and_b32 v117, 31, v117
    v_lshl_add_u32 v118, v117, 4, v118
    buffer_load_dwordx4 v[120:123], v118, s[28:31], 0 offen
    v_add_u32 v117, 1024, v0
    v_lshrrev_b32 v118, 5, v117
    v_add_u32 v118, s50, v118
    v_min_u32 v118, 9999, v118
    v_lshlrev_b32 v118, 9, v118
    v_and_b32 v117, 31, v117
    v_lshl_add_u32 v118, v117, 4, v118
    v_cmp_gt_u32 vcc, 512, v0
    s_and_saveexec_b64 s[50:51], vcc
    buffer_load_dwordx4 v[124:127], v118, s[28:31], 0 offen
    s_mov_b64 exec, s[50:51]
    v_lshrrev_b32 v9, 4, v0
    v_mul_u32_u24 v10, s53, v9
    v_cmp_gt_u32 vcc, s52, v10
    v_cndmask_b32 v4, -1, v4, vcc
    v_lshlrev_b32 v10, 10, v9
    v_add_u32 v10, v10, v1
    ds_write_b128 v10, v[20:23] offset:45056
    ds_write_b128 v10, v[24:27] offset:45312
    ds_write_b128 v10, v[28:31] offset:45568
    ds_write_b128 v10, v[32:35] offset:45824
    v_lshlrev_b32 v11, 2, v9
    ds_write_b32 v11, v4 offset:512
    v_lshlrev_b32 v12, 4, v9
    v_lshrrev_b32 v13, 2, v1
    v_add_u32 v12, v12, v13
    v_cmp_gt_u32 vcc, 64, v1
    s_and_saveexec_b64 s[56:57], vcc
    ds_write_b32 v12, v5 offset:1408
    s_mov_b64 exec, s[56:57]
    s_waitcnt lgkmcnt(0)
    s_barrier
    v_subrev_u32 v13, 4, v11
    v_max_i32 v13, 0, v13
    ds_read_b32 v14, v13 offset:512
    s_waitcnt lgkmcnt(0)
    v_cmp_eq_u32 vcc, 0, v9
    v_cndmask_b32 v14, v14, -2, vcc
    v_cmp_ne_u32 s[56:57], v14, v4
    v_cmp_ne_u32 s[58:59], -1, v4
    s_and_b64 s[56:57], s[56:57], s[58:59]
    s_mov_b64 exec, s[56:57]
    s_cbranch_execz k2_fix_done
    v_add_u32 v15, 1, v9
k2_chain:
    v_cmp_gt_u32 vcc, 64, v15
    s_and_b64 exec, exec, vcc
    s_cbranch_execz k2_chain_done
    v_lshlrev_b32 v13, 2, v15
    ds_read_b32 v14, v13 offset:512
    s_waitcnt lgkmcnt(0)
    v_cmp_eq_u32 vcc, v14, v4
    s_and_b64 exec, exec, vcc
    s_cbranch_execz k2_chain_done
    v_lshlrev_b32 v10, 10, v15
    v_add_u32 v10, v10, v1
    ds_read_b128 v[84:87], v10 offset:45056
    ds_read_b128 v[88:91], v10 offset:45312
    ds_read_b128 v[92:95], v10 offset:45568
    ds_read_b128 v[96:99], v10 offset:45824
    v_lshlrev_b32 v12, 4, v15
    v_lshrrev_b32 v13, 2, v1
    v_add_u32 v12, v12, v13
    ds_read_b32 v16, v12 offset:1408
    s_waitcnt lgkmcnt(0)
    v_add_f32 v20, v20, v84
    v_add_f32 v21, v21, v85
    v_add_f32 v22, v22, v86
    v_add_f32 v23, v23, v87
    v_add_f32 v24, v24, v88
    v_add_f32 v25, v25, v89
    v_add_f32 v26, v26, v90
    v_add_f32 v27, v27, v91
    v_add_f32 v28, v28, v92
    v_add_f32 v29, v29, v93
    v_add_f32 v30, v30, v94
    v_add_f32 v31, v31, v95
    v_add_f32 v32, v32, v96
    v_add_f32 v33, v33, v97
    v_add_f32 v34, v34, v98
    v_add_f32 v35, v35, v99
    v_add_f32 v5, v5, v16
    v_add_u32 v15, 1, v15
    s_branch k2_chain
k2_chain_done:
    s_mov_b64 exec, s[56:57]
    v_add_u32 v10, v4, v1
    ds_read_b128 v[84:87], v10 offset:4096
    ds_read_b128 v[88:91], v10 offset:4352
    ds_read_b128 v[92:95], v10 offset:4608
    ds_read_b128 v[96:99], v10 offset:4864
    v_lshrrev_b32 v12, 6, v4
    v_lshrrev_b32 v13, 2, v1
    v_add_u32 v12, v12, v13
    ds_read_b32 v16, v12 offset:768
    s_waitcnt lgkmcnt(0)
    v_add_f32 v84, v84, v20
    v_add_f32 v85, v85, v21
    v_add_f32 v86, v86, v22
    v_add_f32 v87, v87, v23
    v_add_f32 v88, v88, v24
    v_add_f32 v89, v89, v25
    v_add_f32 v90, v90, v26
    v_add_f32 v91, v91, v27
    v_add_f32 v92, v92, v28
    v_add_f32 v93, v93, v29
    v_add_f32 v94, v94, v30
    v_add_f32 v95, v95, v31
    v_add_f32 v96, v96, v32
    v_add_f32 v97, v97, v33
    v_add_f32 v98, v98, v34
    v_add_f32 v99, v99, v35
    ds_write_b128 v10, v[84:87] offset:4096
    ds_write_b128 v10, v[88:91] offset:4352
    ds_write_b128 v10, v[92:95] offset:4608
    ds_write_b128 v10, v[96:99] offset:4864
    v_add_f32 v16, v16, v5
    v_cmp_gt_u32 vcc, 48, v1
    s_and_b64 exec, exec, vcc
    ds_write_b32 v12, v16 offset:768
k2_fix_done:
    s_mov_b64 exec, -1
    s_waitcnt vmcnt(0)
    v_add_u32 v117, 0, v0
    v_lshrrev_b32 v118, 5, v117
    v_mul_u32_u24 v118, 528, v118
    v_and_b32 v117, 31, v117
    v_lshl_add_u32 v118, v117, 4, v118
    v_add_u32 v118, 112640, v118
    ds_write_b128 v118, v[120:123]
    v_add_u32 v117, 1024, v0
    v_lshrrev_b32 v118, 5, v117
    v_mul_u32_u24 v118, 528, v118
    v_and_b32 v117, 31, v117
    v_lshl_add_u32 v118, v117, 4, v118
    v_add_u32 v118, 112640, v118
    v_cmp_gt_u32 vcc, 512, v0
    s_and_saveexec_b64 s[50:51], vcc
    ds_write_b128 v118, v[124:127]
    s_mov_b64 exec, s[50:51]
    s_waitcnt lgkmcnt(0)
    s_barrier
    v_mov_b32 v10, 2436
    ds_read_b32 v11, v10
    s_waitcnt lgkmcnt(0)
    v_readfirstlane_b32 s49, v11
    s_cmp_eq_u32 s49, 0
    s_cbranch_scc1 k2_epilogue
    s_barrier
    v_mov_b32 v20, 0
    v_lshlrev_b32 v10, 2, v0
    v_cmp_gt_u32 vcc, 128, v0
    s_and_saveexec_b64 s[50:51], vcc
    ds_write_b32 v10, v20 offset:0
    s_mov_b64 exec, s[50:51]
    v_cmp_gt_u32 vcc, 2, v0
    s_and_saveexec_b64 s[50:51], vcc
    ds_write_b32 v10, v20 offset:2432
    s_mov_b64 exec, s[50:51]
    v_lshlrev_b32 v9, 4, v0
    s_branch k2_round0
k2_epilogue:
    v_and_b32 v1, 63, v0
    v_and_b32 v2, 15, v1
    v_lshrrev_b32 v3, 4, v1
    v_add_u32 v4, 0, v0
    v_lshrrev_b32 v5, 5, v4
    v_and_b32 v4, 31, v4
    v_lshlrev_b32 v6, 10, v5
    v_lshl_add_u32 v6, v4, 5, v6
    v_mul_u32_u24 v7, 528, v5
    v_lshl_add_u32 v7, v4, 4, v7
    v_add_u32 v7, 45056, v7
    ds_read_b128 v[8:11], v6 offset:4096
    ds_read_b128 v[12:15], v6 offset:4112
    s_waitcnt lgkmcnt(0)
    v_mul_f32 v8, 0xbf317218, v8
    v_mul_f32 v9, 0xbf317218, v9
    v_mul_f32 v10, 0xbf317218, v10
    v_mul_f32 v11, 0xbf317218, v11
    v_mul_f32 v12, 0xbf317218, v12
    v_mul_f32 v13, 0xbf317218, v13
    v_mul_f32 v14, 0xbf317218, v14
    v_mul_f32 v15, 0xbf317218, v15
    v_cvt_pk_bf16_f32 v8, v8, v9
    v_cvt_pk_bf16_f32 v9, v10, v11
    v_cvt_pk_bf16_f32 v10, v12, v13
    v_cvt_pk_bf16_f32 v11, v14, v15
    ds_write_b128 v7, v[8:11]
    v_add_u32 v4, 1024, v0
    v_lshrrev_b32 v5, 5, v4
    v_and_b32 v4, 31, v4
    v_lshlrev_b32 v6, 10, v5
    v_lshl_add_u32 v6, v4, 5, v6
    v_mul_u32_u24 v7, 528, v5
    v_lshl_add_u32 v7, v4, 4, v7
    v_add_u32 v7, 45056, v7
    v_cmp_gt_u32 vcc, 256, v0
    s_and_saveexec_b64 s[50:51], vcc
    ds_read_b128 v[8:11], v6 offset:4096
    ds_read_b128 v[12:15], v6 offset:4112
    s_waitcnt lgkmcnt(0)
    v_mul_f32 v8, 0xbf317218, v8
    v_mul_f32 v9, 0xbf317218, v9
    v_mul_f32 v10, 0xbf317218, v10
    v_mul_f32 v11, 0xbf317218, v11
    v_mul_f32 v12, 0xbf317218, v12
    v_mul_f32 v13, 0xbf317218, v13
    v_mul_f32 v14, 0xbf317218, v14
    v_mul_f32 v15, 0xbf317218, v15
    v_cvt_pk_bf16_f32 v8, v8, v9
    v_cvt_pk_bf16_f32 v9, v10, v11
    v_cvt_pk_bf16_f32 v10, v12, v13
    v_cvt_pk_bf16_f32 v11, v14, v15
    ds_write_b128 v7, v[8:11]
    s_mov_b64 exec, s[50:51]
    s_waitcnt lgkmcnt(0)
    s_barrier
    s_mul_i32 s50, s2, 40
    v_mul_u32_u24 v5, 528, v2
    v_lshl_add_u32 v5, v3, 4, v5
    v_add_u32 v6, 112640, v5
    v_add_u32 v7, 45056, v5
    ds_read_b128 v[84:87], v6 offset:0
    ds_read_b128 v[88:91], v6 offset:8448
    ds_read_b128 v[92:95], v6 offset:16896
    ds_read_b128 v[116:119], v6 offset:64
    ds_read_b128 v[120:123], v6 offset:8512
    ds_read_b128 v[124:127], v6 offset:16960
    s_waitcnt lgkmcnt(3)
    v_mfma_f32_16x16x32_bf16 v[20:23], v[36:39], v[84:87], 0
    v_mfma_f32_16x16x32_bf16 v[24:27], v[36:39], v[88:91], 0
    v_mfma_f32_16x16x32_bf16 v[28:31], v[36:39], v[92:95], 0
    ds_read_b128 v[84:87], v6 offset:128
    ds_read_b128 v[88:91], v6 offset:8576
    ds_read_b128 v[92:95], v6 offset:17024
    s_waitcnt lgkmcnt(3)
    v_mfma_f32_16x16x32_bf16 v[20:23], v[40:43], v[116:119], v[20:23]
    v_mfma_f32_16x16x32_bf16 v[24:27], v[40:43], v[120:123], v[24:27]
    v_mfma_f32_16x16x32_bf16 v[28:31], v[40:43], v[124:127], v[28:31]
    ds_read_b128 v[116:119], v6 offset:192
    ds_read_b128 v[120:123], v6 offset:8640
    ds_read_b128 v[124:127], v6 offset:17088
    s_waitcnt lgkmcnt(3)
    v_mfma_f32_16x16x32_bf16 v[20:23], v[44:47], v[84:87], v[20:23]
    v_mfma_f32_16x16x32_bf16 v[24:27], v[44:47], v[88:91], v[24:27]
    v_mfma_f32_16x16x32_bf16 v[28:31], v[44:47], v[92:95], v[28:31]
    ds_read_b128 v[84:87], v6 offset:256
    ds_read_b128 v[88:91], v6 offset:8704
    ds_read_b128 v[92:95], v6 offset:17152
    s_waitcnt lgkmcnt(3)
    v_mfma_f32_16x16x32_bf16 v[20:23], v[48:51], v[116:119], v[20:23]
    v_mfma_f32_16x16x32_bf16 v[24:27], v[48:51], v[120:123], v[24:27]
    v_mfma_f32_16x16x32_bf16 v[28:31], v[48:51], v[124:127], v[28:31]
    ds_read_b128 v[116:119], v6 offset:320
    ds_read_b128 v[120:123], v6 offset:8768
    ds_read_b128 v[124:127], v6 offset:17216
    s_waitcnt lgkmcnt(3)
    v_mfma_f32_16x16x32_bf16 v[20:23], v[52:55], v[84:87], v[20:23]
    v_mfma_f32_16x16x32_bf16 v[24:27], v[52:55], v[88:91], v[24:27]
    v_mfma_f32_16x16x32_bf16 v[28:31], v[52:55], v[92:95], v[28:31]
    ds_read_b128 v[84:87], v6 offset:384
    ds_read_b128 v[88:91], v6 offset:8832
    ds_read_b128 v[92:95], v6 offset:17280
    s_waitcnt lgkmcnt(3)
    v_mfma_f32_16x16x32_bf16 v[20:23], v[56:59], v[116:119], v[20:23]
    v_mfma_f32_16x16x32_bf16 v[24:27], v[56:59], v[120:123], v[24:27]
    v_mfma_f32_16x16x32_bf16 v[28:31], v[56:59], v[124:127], v[28:31]
    ds_read_b128 v[116:119], v6 offset:448
    ds_read_b128 v[120:123], v6 offset:8896
    ds_read_b128 v[124:127], v6 offset:17344
    s_waitcnt lgkmcnt(3)
    v_mfma_f32_16x16x32_bf16 v[20:23], v[60:63], v[84:87], v[20:23]
    v_mfma_f32_16x16x32_bf16 v[24:27], v[60:63], v[88:91], v[24:27]
    v_mfma_f32_16x16x32_bf16 v[28:31], v[60:63], v[92:95], v[28:31]
    ds_read_b128 v[84:87], v7 offset:0
    ds_read_b128 v[88:91], v7 offset:8448
    ds_read_b128 v[92:95], v7 offset:16896
    s_waitcnt lgkmcnt(3)
    v_mfma_f32_16x16x32_bf16 v[20:23], v[64:67], v[116:119], v[20:23]
    v_mfma_f32_16x16x32_bf16 v[24:27], v[64:67], v[120:123], v[24:27]
    v_mfma_f32_16x16x32_bf16 v[28:31], v[64:67], v[124:127], v[28:31]
    ds_read_b128 v[116:119], v7 offset:64
    ds_read_b128 v[120:123], v7 offset:8512
    ds_read_b128 v[124:127], v7 offset:16960
    s_waitcnt lgkmcnt(3)
    v_mfma_f32_16x16x32_bf16 v[20:23], v[68:71], v[84:87], v[20:23]
    v_mfma_f32_16x16x32_bf16 v[24:27], v[68:71], v[88:91], v[24:27]
    v_mfma_f32_16x16x32_bf16 v[28:31], v[68:71], v[92:95], v[28:31]
    ds_read_b128 v[84:87], v7 offset:128
    ds_read_b128 v[88:91], v7 offset:8576
    ds_read_b128 v[92:95], v7 offset:17024
    s_waitcnt lgkmcnt(3)
    v_mfma_f32_16x16x32_bf16 v[20:23], v[72:75], v[116:119], v[20:23]
    v_mfma_f32_16x16x32_bf16 v[24:27], v[72:75], v[120:123], v[24:27]
    v_mfma_f32_16x16x32_bf16 v[28:31], v[72:75], v[124:127], v[28:31]
    ds_read_b128 v[116:119], v7 offset:192
    ds_read_b128 v[120:123], v7 offset:8640
    ds_read_b128 v[124:127], v7 offset:17088
    s_waitcnt lgkmcnt(3)
    v_mfma_f32_16x16x32_bf16 v[20:23], v[76:79], v[84:87], v[20:23]
    v_mfma_f32_16x16x32_bf16 v[24:27], v[76:79], v[88:91], v[24:27]
    v_mfma_f32_16x16x32_bf16 v[28:31], v[76:79], v[92:95], v[28:31]
    ds_read_b128 v[84:87], v7 offset:256
    ds_read_b128 v[88:91], v7 offset:8704
    ds_read_b128 v[92:95], v7 offset:17152
    s_waitcnt lgkmcnt(3)
    v_mfma_f32_16x16x32_bf16 v[20:23], v[80:83], v[116:119], v[20:23]
    v_mfma_f32_16x16x32_bf16 v[24:27], v[80:83], v[120:123], v[24:27]
    v_mfma_f32_16x16x32_bf16 v[28:31], v[80:83], v[124:127], v[28:31]
    ds_read_b128 v[116:119], v7 offset:320
    ds_read_b128 v[120:123], v7 offset:8768
    ds_read_b128 v[124:127], v7 offset:17216
    s_waitcnt lgkmcnt(3)
    v_mfma_f32_16x16x32_bf16 v[20:23], v[100:103], v[84:87], v[20:23]
    v_mfma_f32_16x16x32_bf16 v[24:27], v[100:103], v[88:91], v[24:27]
    v_mfma_f32_16x16x32_bf16 v[28:31], v[100:103], v[92:95], v[28:31]
    ds_read_b128 v[84:87], v7 offset:384
    ds_read_b128 v[88:91], v7 offset:8832
    ds_read_b128 v[92:95], v7 offset:17280
    s_waitcnt lgkmcnt(3)
    v_mfma_f32_16x16x32_bf16 v[20:23], v[104:107], v[116:119], v[20:23]
    v_mfma_f32_16x16x32_bf16 v[24:27], v[104:107], v[120:123], v[24:27]
    v_mfma_f32_16x16x32_bf16 v[28:31], v[104:107], v[124:127], v[28:31]
    ds_read_b128 v[116:119], v7 offset:448
    ds_read_b128 v[120:123], v7 offset:8896
    ds_read_b128 v[124:127], v7 offset:17344
    s_waitcnt lgkmcnt(3)
    v_mfma_f32_16x16x32_bf16 v[20:23], v[108:111], v[84:87], v[20:23]
    v_mfma_f32_16x16x32_bf16 v[24:27], v[108:111], v[88:91], v[24:27]
    v_mfma_f32_16x16x32_bf16 v[28:31], v[108:111], v[92:95], v[28:31]
    s_waitcnt lgkmcnt(0)
    v_mfma_f32_16x16x32_bf16 v[20:23], v[112:115], v[116:119], v[20:23]
    v_mfma_f32_16x16x32_bf16 v[24:27], v[112:115], v[120:123], v[24:27]
    v_mfma_f32_16x16x32_bf16 v[28:31], v[112:115], v[124:127], v[28:31]
    s_nop 7
    s_nop 7
    s_lshl_b32 s51, s3, 5
    v_lshlrev_b32 v11, 3, v3
    v_add_u32 v11, s51, v11
    v_mul_u32_u24 v13, 528, v2
    v_add_u32 v13, v13, v11
    v_add_u32 v13, 112640, v13
    v_add_u32 v12, s50, v2
    v_add_u32 v12, 0, v12
    v_lshlrev_b32 v12, 9, v12
    v_add_u32 v12, v12, v11
    ds_read_b64 v[36:37], v13 offset:0
    v_mul_f32 v40, 0xbfb8aa3b, v20
    v_mul_f32 v41, 0xbfb8aa3b, v21
    v_mul_f32 v42, 0xbfb8aa3b, v22
    v_mul_f32 v43, 0xbfb8aa3b, v23
    v_exp_f32 v40, v40
    v_exp_f32 v41, v41
    v_exp_f32 v42, v42
    v_exp_f32 v43, v43
    v_add_f32 v40, 1.0, v40
    v_add_f32 v41, 1.0, v41
    v_add_f32 v42, 1.0, v42
    v_add_f32 v43, 1.0, v43
    v_rcp_f32 v40, v40
    v_rcp_f32 v41, v41
    v_rcp_f32 v42, v42
    v_rcp_f32 v43, v43
    s_nop 0
    v_mul_f32 v20, v20, v40
    v_mul_f32 v21, v21, v41
    v_mul_f32 v22, v22, v42
    v_mul_f32 v23, v23, v43
    s_waitcnt lgkmcnt(0)
    v_lshlrev_b32 v40, 16, v36
    v_and_b32 v41, 0xffff0000, v36
    v_lshlrev_b32 v42, 16, v37
    v_and_b32 v43, 0xffff0000, v37
    v_add_f32 v20, v20, v40
    v_add_f32 v21, v21, v41
    v_add_f32 v22, v22, v42
    v_add_f32 v23, v23, v43
    v_cvt_pk_bf16_f32 v36, v20, v21
    v_cvt_pk_bf16_f32 v37, v22, v23
    buffer_store_dwordx2 v[36:37], v12, s[32:35], 0 offen
    v_add_u32 v12, s50, v2
    v_add_u32 v12, 16, v12
    v_lshlrev_b32 v12, 9, v12
    v_add_u32 v12, v12, v11
    ds_read_b64 v[36:37], v13 offset:8448
    v_mul_f32 v40, 0xbfb8aa3b, v24
    v_mul_f32 v41, 0xbfb8aa3b, v25
    v_mul_f32 v42, 0xbfb8aa3b, v26
    v_mul_f32 v43, 0xbfb8aa3b, v27
    v_exp_f32 v40, v40
    v_exp_f32 v41, v41
    v_exp_f32 v42, v42
    v_exp_f32 v43, v43
    v_add_f32 v40, 1.0, v40
    v_add_f32 v41, 1.0, v41
    v_add_f32 v42, 1.0, v42
    v_add_f32 v43, 1.0, v43
    v_rcp_f32 v40, v40
    v_rcp_f32 v41, v41
    v_rcp_f32 v42, v42
    v_rcp_f32 v43, v43
    s_nop 0
    v_mul_f32 v24, v24, v40
    v_mul_f32 v25, v25, v41
    v_mul_f32 v26, v26, v42
    v_mul_f32 v27, v27, v43
    s_waitcnt lgkmcnt(0)
    v_lshlrev_b32 v40, 16, v36
    v_and_b32 v41, 0xffff0000, v36
    v_lshlrev_b32 v42, 16, v37
    v_and_b32 v43, 0xffff0000, v37
    v_add_f32 v24, v24, v40
    v_add_f32 v25, v25, v41
    v_add_f32 v26, v26, v42
    v_add_f32 v27, v27, v43
    v_cvt_pk_bf16_f32 v36, v24, v25
    v_cvt_pk_bf16_f32 v37, v26, v27
    buffer_store_dwordx2 v[36:37], v12, s[32:35], 0 offen
    v_add_u32 v12, s50, v2
    v_add_u32 v12, 32, v12
    v_lshlrev_b32 v12, 9, v12
    v_add_u32 v12, v12, v11
    v_cmp_gt_u32 vcc, 8, v2
    s_and_saveexec_b64 s[56:57], vcc
    ds_read_b64 v[36:37], v13 offset:16896
    v_mul_f32 v40, 0xbfb8aa3b, v28
    v_mul_f32 v41, 0xbfb8aa3b, v29
    v_mul_f32 v42, 0xbfb8aa3b, v30
    v_mul_f32 v43, 0xbfb8aa3b, v31
    v_exp_f32 v40, v40
    v_exp_f32 v41, v41
    v_exp_f32 v42, v42
    v_exp_f32 v43, v43
    v_add_f32 v40, 1.0, v40
    v_add_f32 v41, 1.0, v41
    v_add_f32 v42, 1.0, v42
    v_add_f32 v43, 1.0, v43
    v_rcp_f32 v40, v40
    v_rcp_f32 v41, v41
    v_rcp_f32 v42, v42
    v_rcp_f32 v43, v43
    s_nop 0
    v_mul_f32 v28, v28, v40
    v_mul_f32 v29, v29, v41
    v_mul_f32 v30, v30, v42
    v_mul_f32 v31, v31, v43
    s_waitcnt lgkmcnt(0)
    v_lshlrev_b32 v40, 16, v36
    v_and_b32 v41, 0xffff0000, v36
    v_lshlrev_b32 v42, 16, v37
    v_and_b32 v43, 0xffff0000, v37
    v_add_f32 v28, v28, v40
    v_add_f32 v29, v29, v41
    v_add_f32 v30, v30, v42
    v_add_f32 v31, v31, v43
    v_cvt_pk_bf16_f32 v36, v28, v29
    v_cvt_pk_bf16_f32 v37, v30, v31
    buffer_store_dwordx2 v[36:37], v12, s[32:35], 0 offen
    s_mov_b64 exec, s[56:57]
    v_cmp_gt_u32 vcc, 120, v0
    s_and_saveexec_b64 s[56:57], vcc
    s_cbranch_execz k2_end
    v_mul_u32_u24 v12, 21846, v0
    v_lshrrev_b32 v12, 16, v12
    v_mul_u32_u24 v13, 3, v12
    v_sub_u32 v13, v0, v13
    v_lshlrev_b32 v14, 4, v12
    v_lshlrev_b32 v15, 2, v13
    v_add_u32 v14, v14, v15
    ds_read_b32 v16, v14 offset:768
    s_mul_i32 s51, s2, 240
    v_lshlrev_b32 v17, 1, v0
    buffer_load_ushort v18, v17, s[36:39], s51 offen
    s_waitcnt vmcnt(0) lgkmcnt(0)
    v_lshlrev_b32 v18, 16, v18
    v_mul_f32 v16, 0xbf317218, v16
    v_add_f32 v16, v16, v18
    v_cvt_pk_bf16_f32 v16, v16, v16
    s_add_u32 s51, s51, 5120000
    buffer_store_short v16, v17, s[32:35], s51 offen
k2_end:
    s_endpgm
.section .rodata,"a"
.p2align 6

.amdhsa_kernel k1_kernel
  .amdhsa_next_free_vgpr 248
  .amdhsa_next_free_sgpr 100
  .amdhsa_accum_offset 248
  .amdhsa_group_segment_fixed_size 0
  .amdhsa_kernarg_size 88
  .amdhsa_user_sgpr_count 2
  .amdhsa_user_sgpr_kernarg_segment_ptr 1
  .amdhsa_system_sgpr_workgroup_id_x 1
.end_amdhsa_kernel
.p2align 6

.amdhsa_kernel k2_kernel
  .amdhsa_next_free_vgpr 128
  .amdhsa_next_free_sgpr 100
  .amdhsa_accum_offset 128
  .amdhsa_group_segment_fixed_size 0
  .amdhsa_kernarg_size 88
  .amdhsa_user_sgpr_count 2
  .amdhsa_user_sgpr_kernarg_segment_ptr 1
  .amdhsa_system_sgpr_workgroup_id_x 1
.end_amdhsa_kernel
```
